```python
import torch

def _softmax(x, axis=-1):
    return torch.softmax(x, dim=axis)
def _gelu(x):
    return torch.nn.functional.gelu(x, approximate="tanh")
def _silu(x):
    return torch.nn.functional.silu(x)
def _sigmoid(x):
    return torch.sigmoid(x)
def _layernorm(x, axis=-1, eps=1e-5):
    m = x.mean(dim=axis, keepdim=True)
    v = x.var(dim=axis, keepdim=True, unbiased=False)
    return (x - m) / torch.sqrt(v + eps)
def _scatter_add(tgt, idx, src, axis=0):
    return tgt.clone().index_add_(axis, idx, src)
def _segment_sum(src, seg, n):
    out = torch.zeros((n,) + src.shape[1:], dtype=src.dtype)
    return out.index_add_(0, seg, src)
def _pad(x, pw):
    flat = tuple(v for pair in reversed(pw) for v in pair)
    return torch.nn.functional.pad(x, flat)

kernel_name = 'gated_mix__sliding_local_dilated__softmax_full_mha__prompt'

def setup_inputs():

    _w = (lambda a: (lambda t: t.to(torch.bfloat16) if t.is_floating_point() else t)(torch.as_tensor(a)))
    def _A_setup():
        B, S, D = 1, 2048, 640
        return {
            "x": _w((lambda *s: torch.randn(*s, dtype=torch.bfloat16) * 0.05)(B, S, D)),
            "wqkv": _w((lambda *s: torch.randn(*s, dtype=torch.bfloat16) * 1.6)(D, 3 * D)),
            "wo": _w((lambda *s: torch.randn(*s, dtype=torch.bfloat16) * 0.05)(D, D)),
        }
    _A_in = _A_setup()

    def _B_setup():
        B, S, D = 1, 2048, 640
        return {
            "x": _w((lambda *s: torch.randn(*s, dtype=torch.bfloat16) * 0.05)(B, S, D)),
            "wqkv": _w((lambda *s: torch.randn(*s, dtype=torch.bfloat16) * 1.6)(D, 3 * D)),
            "wo": _w((lambda *s: torch.randn(*s, dtype=torch.bfloat16) * 0.1)(D, D)),
        }
    _B_in = _B_setup()

    return {
        "A_x": _A_in["x"],
        "A_wqkv": _A_in["wqkv"],
        "A_wo": _A_in["wo"],
        "B_x": _B_in["x"],
        "B_wqkv": _B_in["wqkv"],
        "B_wo": _B_in["wo"],
        "gate_w": _w((lambda *s: torch.randn(*s, dtype=torch.bfloat16) * 0.05)(640) * 16.0),
    }

def reference(A_x, A_wqkv, A_wo, B_x, B_wqkv, B_wo, gate_w):
    def _A_ref(x, wqkv, wo):
        B, S, D = x.shape
        H = 32; Dh = D // H
        W, dil = 8, 2
        qkv = (lambda x, *d: x.permute(*d))((x @ wqkv).reshape(B, S, 3, H, Dh), 2, 0, 3, 1, 4)
        q, k, v = qkv[0], qkv[1], qkv[2]
        scale = Dh ** -0.5
        pos = torch.arange(S)
        off = torch.arange(W) * dil
        idx = pos[:, None] - off[None, :]
        mask = idx >= 0
        idx_c = torch.where(mask, idx, 0).reshape(-1)
        kg = k[:, :, idx_c, :].reshape(B, H, S, W, Dh)
        vg = v[:, :, idx_c, :].reshape(B, H, S, W, Dh)
        logits = torch.einsum("bhsd,bhswd->bhsw", q, kg) * scale
        logits = torch.where(mask[None, None, :, :], logits, -1e9)
        attn = _softmax(logits, axis=-1)
        o = torch.einsum("bhsw,bhswd->bhsd", attn, vg)
        return (lambda x, *d: x.permute(*d))(o, 0, 2, 1, 3).reshape(B, S, D) @ wo

    def _B_ref(x, wqkv, wo):
        B, S, D = x.shape
        H = 32; Dh = D // H
        qkv = (lambda x, *d: x.permute(*d))((x @ wqkv).reshape(B, S, 3, H, Dh), 2, 0, 3, 1, 4)
        q, k, v = qkv[0], qkv[1], qkv[2]
        scale = Dh ** -0.5
        scores = torch.einsum("bhqd,bhkd->bhqk", q, k) * scale
        p = _softmax(scores, axis=-1)
        o = torch.einsum("bhqk,bhkd->bhqd", p, v)
        return (lambda x, *d: x.permute(*d))(o, 0, 2, 1, 3).reshape(B, S, D) @ wo

    x = A_x
    g = _sigmoid((x * gate_w).sum(-1, keepdims=True))
    a = _A_ref(x, A_wqkv, A_wo)
    b = _B_ref(x, B_wqkv, B_wo)
    return g * a + (1 - g) * b
```

```asm
; @launch grid=(256,1,1) block=(512,1,1) lds=163840
.amdgcn_target "amdgcn-amd-amdhsa--gfx950"
.text
.globl gated_mix__sliding_local_dilated__softmax_full_mha__prompt_kernel
.p2align 8
.type gated_mix__sliding_local_dilated__softmax_full_mha__prompt_kernel,@function
gated_mix__sliding_local_dilated__softmax_full_mha__prompt_kernel:
    s_cmp_ge_u32 s2, 256
    s_cbranch_scc1 F_END
    s_setprio 3
    s_load_dwordx4 s[36:39], s[0:1], 0
    s_load_dwordx2 s[40:41], s[0:1], 32
    s_load_dwordx2 s[58:59], s[0:1], 56
    s_load_dwordx2 s[60:61], s[0:1], 64
    s_load_dwordx2 s[42:43], s[0:1], 72
    s_memrealtime s[34:35]
    v_and_b32 v1, 63, v0
    v_lshrrev_b32 v2, 6, v0
    s_mov_b32 s20, 0x000FFFFF
    v_readfirstlane_b32 s16, v2
    s_mov_b32 s21, 0x000FFFFF
    s_mov_b32 s22, -1
    s_mov_b32 s23, 0
    s_mov_b32 s56, 0
    s_mov_b32 s57, -1
    s_mov_b32 s62, 0
    s_and_b32 s30, s2, 7
    s_lshr_b32 s31, s2, 3
    s_waitcnt lgkmcnt(0)
    s_mov_b32 s8, s42
    s_mov_b32 s9, s43
    s_mov_b32 s10, 23920640
    s_mov_b32 s11, 0x20000
    s_mov_b32 s12, s60
    s_mov_b32 s13, s61
    s_mov_b32 s14, 256
    s_mov_b32 s15, 0x20000
    s_or_b32 s33, s2, s16
    s_cmp_lg_u32 s33, 0
    s_cbranch_scc1 P1_NOTAG
    s_memrealtime s[62:63]
    s_waitcnt lgkmcnt(0)
    s_or_b32 s62, s62, 1
    v_mov_b32 v6, 0
    v_mov_b32 v7, s62
    s_mov_b64 exec, 1
    buffer_store_dword v7, v6, s[12:15], 0 offen sc1
    s_mov_b64 exec, -1
P1_NOTAG:
    s_cmp_ge_u32 s31, 30
    s_cbranch_scc1 P1_SPARE
    s_mul_i32 s30, s30, 30
    s_add_u32 s30, s30, s31
    s_and_b32 s19, s30, 7
    s_cmp_ge_u32 s30, 120
    s_cselect_b32 s31, 120, 0
    s_cselect_b32 s54, 8, 0
    s_sub_u32 s30, s30, s31
    s_add_u32 s19, s19, s54
    s_lshr_b32 s49, s30, 3
    s_lshr_b32 s51, s16, 2
    s_mov_b32 s50, 0
    s_cmp_ge_u32 s49, 5
    s_cselect_b32 s50, 1, s50
    s_cmp_ge_u32 s49, 10
    s_cselect_b32 s50, 2, s50
    s_mul_i32 s31, s50, 5
    s_sub_u32 s52, s49, s31
    s_and_b32 s17, s16, 1
    s_bfe_u32 s18, s16, 0x10001
    s_mov_b32 s4, s36
    s_mov_b32 s5, s37
    s_mov_b32 s6, 2621440
    s_mov_b32 s7, 0x20000
    s_mov_b32 s44, s40
    s_mov_b32 s45, s41
    s_mov_b32 s46, 2457600
    s_mov_b32 s47, 0x20000
    s_mov_b32 s41, s34
    s_mov_b32 s36, s38
    s_mov_b32 s37, s39
    s_mov_b32 s38, 2457600
    s_mov_b32 s39, 0x20000
    s_lshl_b32 s30, s19, 7
    s_and_b32 s31, s16, 3
    s_lshl_b32 s31, s31, 5
    s_add_u32 s30, s30, s31
    s_add_u32 s30, s30, s51
    s_mul_i32 s54, s30, 1280
    v_lshrrev_b32 v2, 3, v1
    v_mul_u32_u24 v2, 2560, v2
    v_add_u32 v2, s54, v2
    v_and_b32 v3, 7, v1
    v_lshrrev_b32 v4, 4, v1
    v_xor_b32 v5, v3, v4
    v_xor_b32 v6, 4, v5
    v_lshlrev_b32 v5, 4, v5
    v_lshlrev_b32 v6, 4, v6
    v_add_u32 v10, v2, v5
    v_add_u32 v11, v2, v6
    v_add_u32 v11, 19456, v11
    s_lshl_b32 s30, s16, 3
    v_add_u32 v2, s30, v4
    v_mul_u32_u24 v2, 3840, v2
    v_and_b32 v3, 15, v1
    v_lshlrev_b32 v5, 2, v4
    v_xor_b32 v3, v3, v5
    v_lshlrev_b32 v3, 4, v3
    v_add_u32 v2, v2, v3
    s_lshl_b32 s30, s49, 8
    v_add_u32 v14, s30, v2
    v_add_u32 v15, 14336, v14
    s_lshl_b32 s28, s16, 11
    s_add_u32 s29, s28, 16384
    s_mov_b32 s24, 0
    s_mov_b32 s25, 0
    s_add_u32 m0, s28, 0
    s_nop 0
    buffer_load_dwordx4 v10, s[4:7], s24 offen offset:0  lds
    buffer_load_dwordx4 v11, s[4:7], s24 offen offset:1024  lds
    s_add_u32 m0, s29, 0
    s_nop 0
    buffer_load_dwordx4 v14, s[44:47], s25 offen offset:0  lds
    buffer_load_dwordx4 v15, s[44:47], s25 offen offset:1024  lds
    s_add_u32 m0, s29, 16384
    s_nop 0
    buffer_load_dwordx4 v14, s[36:39], s25 offen offset:0  lds
    buffer_load_dwordx4 v15, s[36:39], s25 offen offset:1024  lds
    s_add_u32 s24, s24, 128
    s_add_u32 s25, s25, 245760
    v_and_b32 v2, 31, v1
    s_lshl_b32 s30, s17, 6
    v_add_u32 v3, s30, v2
    v_lshlrev_b32 v3, 7, v3
    v_lshrrev_b32 v4, 5, v1
    v_bfe_u32 v5, v1, 1, 3
    v_xor_b32 v5, v4, v5
    v_lshlrev_b32 v5, 4, v5
    v_add_u32 v16, v3, v5
    v_xor_b32 v17, 32, v16
    v_xor_b32 v18, 64, v16
    v_xor_b32 v19, 96, v16
    v_bfe_u32 v5, v1, 2, 2
    v_lshlrev_b32 v6, 3, v4
    v_add_u32 v6, v6, v5
    v_lshlrev_b32 v6, 8, v6
    v_bfe_u32 v7, v1, 4, 1
    v_lshlrev_b32 v7, 1, v7
    v_bfe_u32 v8, v1, 1, 1
    v_add_u32 v7, v7, v8
    s_lshl_b32 s30, s18, 3
    v_add_u32 v7, s30, v7
    v_lshlrev_b32 v5, 2, v5
    v_xor_b32 v7, v7, v5
    v_lshlrev_b32 v7, 4, v7
    v_and_b32 v8, 1, v1
    v_lshlrev_b32 v8, 3, v8
    v_add3_u32 v6, v6, v7, v8
    s_lshl_b32 s30, s51, 14
    s_add_u32 s30, s30, 16384
    v_add_u32 v20, s30, v6
    v_xor_b32 v21, 64, v20
    s_add_u32 m0, s28, 49152
    s_nop 0
    buffer_load_dwordx4 v10, s[4:7], s24 offen offset:0  lds
    buffer_load_dwordx4 v11, s[4:7], s24 offen offset:1024  lds
    s_add_u32 m0, s29, 49152
    s_nop 0
    buffer_load_dwordx4 v14, s[44:47], s25 offen offset:0  lds
    buffer_load_dwordx4 v15, s[44:47], s25 offen offset:1024  lds
    s_add_u32 m0, s29, 65536
    s_nop 0
    buffer_load_dwordx4 v14, s[36:39], s25 offen offset:0  lds
    buffer_load_dwordx4 v15, s[36:39], s25 offen offset:1024  lds
    s_add_u32 s24, s24, 128
    s_add_u32 s25, s25, 245760
    v_mov_b32 v6, 0
    buffer_load_dword v22, v6, s[12:15], 0 offen sc1
    v_mov_b32 v64, 0
    v_mov_b32 v65, 0
    v_mov_b32 v66, 0
    v_mov_b32 v67, 0
    v_mov_b32 v68, 0
    v_mov_b32 v69, 0
    v_mov_b32 v70, 0
    v_mov_b32 v71, 0
    v_mov_b32 v72, 0
    v_mov_b32 v73, 0
    v_mov_b32 v74, 0
    v_mov_b32 v75, 0
    v_mov_b32 v76, 0
    v_mov_b32 v77, 0
    v_mov_b32 v78, 0
    v_mov_b32 v79, 0
    v_mov_b32 v80, 0
    v_mov_b32 v81, 0
    v_mov_b32 v82, 0
    v_mov_b32 v83, 0
    v_mov_b32 v84, 0
    v_mov_b32 v85, 0
    v_mov_b32 v86, 0
    v_mov_b32 v87, 0
    v_mov_b32 v88, 0
    v_mov_b32 v89, 0
    v_mov_b32 v90, 0
    v_mov_b32 v91, 0
    v_mov_b32 v92, 0
    v_mov_b32 v93, 0
    v_mov_b32 v94, 0
    v_mov_b32 v95, 0
    v_mov_b32 v96, 0
    v_mov_b32 v97, 0
    v_mov_b32 v98, 0
    v_mov_b32 v99, 0
    v_mov_b32 v100, 0
    v_mov_b32 v101, 0
    v_mov_b32 v102, 0
    v_mov_b32 v103, 0
    v_mov_b32 v104, 0
    v_mov_b32 v105, 0
    v_mov_b32 v106, 0
    v_mov_b32 v107, 0
    v_mov_b32 v108, 0
    v_mov_b32 v109, 0
    v_mov_b32 v110, 0
    v_mov_b32 v111, 0
    v_mov_b32 v112, 0
    v_mov_b32 v113, 0
    v_mov_b32 v114, 0
    v_mov_b32 v115, 0
    v_mov_b32 v116, 0
    v_mov_b32 v117, 0
    v_mov_b32 v118, 0
    v_mov_b32 v119, 0
    v_mov_b32 v120, 0
    v_mov_b32 v121, 0
    v_mov_b32 v122, 0
    v_mov_b32 v123, 0
    v_mov_b32 v124, 0
    v_mov_b32 v125, 0
    v_mov_b32 v126, 0
    v_mov_b32 v127, 0
    s_cmp_eq_u32 s51, 0
    s_mov_b32 s30, 1310720
    s_cselect_b32 s30, 3932160, s30
    s_mov_b32 s31, 6553600
    s_cselect_b32 s31, 11796480, s31
    s_cmp_eq_u32 s50, 0
    s_cselect_b32 s54, s30, s31
    s_mov_b32 s35, 2560
    s_cselect_b32 s35, 1280, s35
    s_lshl_b32 s53, s35, 6
    s_lshl_b32 s30, s17, 5
    s_lshl_b32 s31, s19, 1
    s_add_u32 s30, s30, s31
    s_mul_i32 s33, s30, s35
    s_add_u32 s33, s33, s54
    s_add_u32 s34, s33, s35
    s_cmp_eq_u32 s50, 2
    s_cbranch_scc1 P1_VPATH
    v_lshrrev_b32 v4, 5, v1
    s_lshl_b32 s30, s52, 4
    s_lshl_b32 s31, s18, 3
    s_add_u32 s30, s30, s31
    v_add_u32 v2, s30, v4
    v_and_b32 v3, 31, v1
    v_lshlrev_b32 v8, 4, v3
    v_lshrrev_b32 v9, 4, v3
    v_mul_lo_u32 v9, v9, s53
    v_and_b32 v56, 15, v3
    v_lshlrev_b32 v56, 4, v56
    v_add3_u32 v9, v9, v56, 0
    v_add_u32 v9, 1024, v9
    v_add_u32 v5, 0, v2
    v_mul_u32_u24 v6, 13108, v5
    v_lshrrev_b32 v6, 16, v6
    v_mul_u32_u24 v7, 5, v6
    v_sub_u32 v5, v5, v7
    v_lshlrev_b32 v6, 1, v6
    v_mul_lo_u32 v23, v6, s53
    v_cmp_le_u32 vcc, 3, v5
    v_subrev_u32 v7, 3, v5
    v_add_u32 v56, s53, v23
    v_cndmask_b32 v7, v5, v7, vcc
    v_cndmask_b32 v56, v23, v56, vcc
    v_lshlrev_b32 v7, 9, v7
    v_add3_u32 v56, v56, v7, v8
    v_cmp_eq_u32 vcc, 2, v5
    v_add_u32 v23, v23, v9
    s_nop 0
    v_cndmask_b32 v56, v56, v23, vcc
    v_add_u32 v200, s33, v56
    v_add_u32 v201, s34, v56
    v_add_u32 v5, 2, v2
    v_mul_u32_u24 v6, 13108, v5
    v_lshrrev_b32 v6, 16, v6
    v_mul_u32_u24 v7, 5, v6
    v_sub_u32 v5, v5, v7
    v_lshlrev_b32 v6, 1, v6
    v_mul_lo_u32 v23, v6, s53
    v_cmp_le_u32 vcc, 3, v5
    v_subrev_u32 v7, 3, v5
    v_add_u32 v56, s53, v23
    v_cndmask_b32 v7, v5, v7, vcc
    v_cndmask_b32 v56, v23, v56, vcc
    v_lshlrev_b32 v7, 9, v7
    v_add3_u32 v56, v56, v7, v8
    v_cmp_eq_u32 vcc, 2, v5
    v_add_u32 v23, v23, v9
    s_nop 0
    v_cndmask_b32 v56, v56, v23, vcc
    v_add_u32 v202, s33, v56
    v_add_u32 v203, s34, v56
    v_add_u32 v5, 4, v2
    v_mul_u32_u24 v6, 13108, v5
    v_lshrrev_b32 v6, 16, v6
    v_mul_u32_u24 v7, 5, v6
    v_sub_u32 v5, v5, v7
    v_lshlrev_b32 v6, 1, v6
    v_mul_lo_u32 v23, v6, s53
    v_cmp_le_u32 vcc, 3, v5
    v_subrev_u32 v7, 3, v5
    v_add_u32 v56, s53, v23
    v_cndmask_b32 v7, v5, v7, vcc
    v_cndmask_b32 v56, v23, v56, vcc
    v_lshlrev_b32 v7, 9, v7
    v_add3_u32 v56, v56, v7, v8
    v_cmp_eq_u32 vcc, 2, v5
    v_add_u32 v23, v23, v9
    s_nop 0
    v_cndmask_b32 v56, v56, v23, vcc
    v_add_u32 v204, s33, v56
    v_add_u32 v205, s34, v56
    v_add_u32 v5, 6, v2
    v_mul_u32_u24 v6, 13108, v5
    v_lshrrev_b32 v6, 16, v6
    v_mul_u32_u24 v7, 5, v6
    v_sub_u32 v5, v5, v7
    v_lshlrev_b32 v6, 1, v6
    v_mul_lo_u32 v23, v6, s53
    v_cmp_le_u32 vcc, 3, v5
    v_subrev_u32 v7, 3, v5
    v_add_u32 v56, s53, v23
    v_cndmask_b32 v7, v5, v7, vcc
    v_cndmask_b32 v56, v23, v56, vcc
    v_lshlrev_b32 v7, 9, v7
    v_add3_u32 v56, v56, v7, v8
    v_cmp_eq_u32 vcc, 2, v5
    v_add_u32 v23, v23, v9
    s_nop 0
    v_cndmask_b32 v56, v56, v23, vcc
    v_add_u32 v206, s33, v56
    v_add_u32 v207, s34, v56
    s_waitcnt vmcnt(7)
    s_barrier
    ds_read_b128 v[24:27], v16 offset:0
    ds_read_b128 v[28:31], v16 offset:4096
    ds_read_b64_tr_b16 v[32:33], v20 offset:0
    ds_read_b64_tr_b16 v[34:35], v20 offset:1024
    ds_read_b64_tr_b16 v[36:37], v21 offset:0
    ds_read_b64_tr_b16 v[38:39], v21 offset:1024
    s_mov_b32 s26, 0
    s_mov_b32 s27, 0
    s_mov_b32 s48, 98304
.p2align 2
P1_LOOP_QK:
    s_cmp_le_u32 s26, 7
    s_cselect_b64 vcc, -1, 0
    ds_read_b128 v[40:43], v17 offset:0
    ds_read_b128 v[44:47], v17 offset:4096
    ds_read_b64_tr_b16 v[48:49], v20 offset:4096
    ds_read_b64_tr_b16 v[50:51], v20 offset:5120
    ds_read_b64_tr_b16 v[52:53], v21 offset:4096
    ds_read_b64_tr_b16 v[54:55], v21 offset:5120
    s_waitcnt lgkmcnt(6)
    v_mfma_f32_32x32x16_bf16 v[64:79], v[32:35], v[24:27], v[64:79]
    s_cbranch_vccz P1_ND_QK_1
    s_add_u32 m0, s48, s28
    s_nop 0
    buffer_load_dwordx4 v10, s[4:7], s24 offen offset:0  lds
P1_ND_QK_1:
    v_mfma_f32_32x32x16_bf16 v[80:95], v[36:39], v[24:27], v[80:95]
    s_cbranch_vccz P1_ND_QK_2
    buffer_load_dwordx4 v11, s[4:7], s24 offen offset:1024  lds
P1_ND_QK_2:
    v_mfma_f32_32x32x16_bf16 v[96:111], v[32:35], v[28:31], v[96:111]
    v_mfma_f32_32x32x16_bf16 v[112:127], v[36:39], v[28:31], v[112:127]
    ds_read_b128 v[24:27], v18 offset:0
    ds_read_b128 v[28:31], v18 offset:4096
    ds_read_b64_tr_b16 v[32:33], v20 offset:8192
    ds_read_b64_tr_b16 v[34:35], v20 offset:9216
    ds_read_b64_tr_b16 v[36:37], v21 offset:8192
    ds_read_b64_tr_b16 v[38:39], v21 offset:9216
    s_waitcnt lgkmcnt(6)
    v_mfma_f32_32x32x16_bf16 v[64:79], v[48:51], v[40:43], v[64:79]
    s_cbranch_vccz P1_ND_QK_3
    s_add_u32 m0, s48, s29
    s_nop 0
    buffer_load_dwordx4 v14, s[44:47], s25 offen offset:0  lds
P1_ND_QK_3:
    v_mfma_f32_32x32x16_bf16 v[80:95], v[52:55], v[40:43], v[80:95]
    s_cbranch_vccz P1_ND_QK_4
    buffer_load_dwordx4 v15, s[44:47], s25 offen offset:1024  lds
P1_ND_QK_4:
    v_mfma_f32_32x32x16_bf16 v[96:111], v[48:51], v[44:47], v[96:111]
    v_mfma_f32_32x32x16_bf16 v[112:127], v[52:55], v[44:47], v[112:127]
    ds_read_b128 v[40:43], v19 offset:0
    ds_read_b128 v[44:47], v19 offset:4096
    ds_read_b64_tr_b16 v[48:49], v20 offset:12288
    ds_read_b64_tr_b16 v[50:51], v20 offset:13312
    ds_read_b64_tr_b16 v[52:53], v21 offset:12288
    ds_read_b64_tr_b16 v[54:55], v21 offset:13312
    s_waitcnt lgkmcnt(6)
    v_mfma_f32_32x32x16_bf16 v[64:79], v[32:35], v[24:27], v[64:79]
    s_cbranch_vccz P1_ND_QK_5
    s_add_u32 m0, s48, s29
    s_add_u32 m0, m0, 16384
    s_nop 0
    buffer_load_dwordx4 v14, s[36:39], s25 offen offset:0  lds
P1_ND_QK_5:
    v_mfma_f32_32x32x16_bf16 v[80:95], v[36:39], v[24:27], v[80:95]
    s_cbranch_vccz P1_ND_QK_6
    buffer_load_dwordx4 v15, s[36:39], s25 offen offset:1024  lds
    s_add_u32 s24, s24, 128
    s_add_u32 s25, s25, 245760
P1_ND_QK_6:
    v_mfma_f32_32x32x16_bf16 v[96:111], v[32:35], v[28:31], v[96:111]
    v_mfma_f32_32x32x16_bf16 v[112:127], v[36:39], v[28:31], v[112:127]
    s_cmp_eq_u32 s27, 98304
    s_mov_b32 s32, 49152
    s_cselect_b32 s32, 4294868992, s32
    v_add_u32 v16, s32, v16
    v_add_u32 v17, s32, v17
    v_add_u32 v18, s32, v18
    v_add_u32 v19, s32, v19
    v_add_u32 v20, s32, v20
    v_add_u32 v21, s32, v21
    s_cmp_eq_u32 s26, 9
    s_cbranch_scc1 P1_LAST_QK
    s_cmp_ge_u32 s26, 8
    s_cbranch_scc1 P1_W0_QK
    s_waitcnt vmcnt(6) lgkmcnt(0)
    s_branch P1_W1_QK
P1_W0_QK:
    s_waitcnt vmcnt(0) lgkmcnt(0)
P1_W1_QK:
    s_barrier
    ds_read_b128 v[24:27], v16 offset:0
    ds_read_b128 v[28:31], v16 offset:4096
    ds_read_b64_tr_b16 v[32:33], v20 offset:0
    ds_read_b64_tr_b16 v[34:35], v20 offset:1024
    ds_read_b64_tr_b16 v[36:37], v21 offset:0
    ds_read_b64_tr_b16 v[38:39], v21 offset:1024
    v_mfma_f32_32x32x16_bf16 v[64:79], v[48:51], v[40:43], v[64:79]
    v_mfma_f32_32x32x16_bf16 v[80:95], v[52:55], v[40:43], v[80:95]
    v_mfma_f32_32x32x16_bf16 v[96:111], v[48:51], v[44:47], v[96:111]
    v_mfma_f32_32x32x16_bf16 v[112:127], v[52:55], v[44:47], v[112:127]
    s_mov_b32 s48, s27
    s_add_u32 s27, s27, s32
    s_add_u32 s26, s26, 1
    s_branch P1_LOOP_QK
P1_LAST_QK:
    s_waitcnt lgkmcnt(0)
    v_mfma_f32_32x32x16_bf16 v[64:79], v[48:51], v[40:43], v[64:79]
    v_mfma_f32_32x32x16_bf16 v[80:95], v[52:55], v[40:43], v[80:95]
    v_mfma_f32_32x32x16_bf16 v[96:111], v[48:51], v[44:47], v[96:111]
    v_mfma_f32_32x32x16_bf16 v[112:127], v[52:55], v[44:47], v[112:127]
    s_nop 12
    s_cmp_eq_u32 s50, 0
    s_cbranch_scc0 P1_NOSC
    s_mov_b32 s30, 1051011932
    v_mul_f32 v64, s30, v64
    v_mul_f32 v65, s30, v65
    v_mul_f32 v66, s30, v66
    v_mul_f32 v67, s30, v67
    v_mul_f32 v68, s30, v68
    v_mul_f32 v69, s30, v69
    v_mul_f32 v70, s30, v70
    v_mul_f32 v71, s30, v71
    v_mul_f32 v72, s30, v72
    v_mul_f32 v73, s30, v73
    v_mul_f32 v74, s30, v74
    v_mul_f32 v75, s30, v75
    v_mul_f32 v76, s30, v76
    v_mul_f32 v77, s30, v77
    v_mul_f32 v78, s30, v78
    v_mul_f32 v79, s30, v79
    v_mul_f32 v80, s30, v80
    v_mul_f32 v81, s30, v81
    v_mul_f32 v82, s30, v82
    v_mul_f32 v83, s30, v83
    v_mul_f32 v84, s30, v84
    v_mul_f32 v85, s30, v85
    v_mul_f32 v86, s30, v86
    v_mul_f32 v87, s30, v87
    v_mul_f32 v88, s30, v88
    v_mul_f32 v89, s30, v89
    v_mul_f32 v90, s30, v90
    v_mul_f32 v91, s30, v91
    v_mul_f32 v92, s30, v92
    v_mul_f32 v93, s30, v93
    v_mul_f32 v94, s30, v94
    v_mul_f32 v95, s30, v95
    v_mul_f32 v96, s30, v96
    v_mul_f32 v97, s30, v97
    v_mul_f32 v98, s30, v98
    v_mul_f32 v99, s30, v99
    v_mul_f32 v100, s30, v100
    v_mul_f32 v101, s30, v101
    v_mul_f32 v102, s30, v102
    v_mul_f32 v103, s30, v103
    v_mul_f32 v104, s30, v104
    v_mul_f32 v105, s30, v105
    v_mul_f32 v106, s30, v106
    v_mul_f32 v107, s30, v107
    v_mul_f32 v108, s30, v108
    v_mul_f32 v109, s30, v109
    v_mul_f32 v110, s30, v110
    v_mul_f32 v111, s30, v111
    v_mul_f32 v112, s30, v112
    v_mul_f32 v113, s30, v113
    v_mul_f32 v114, s30, v114
    v_mul_f32 v115, s30, v115
    v_mul_f32 v116, s30, v116
    v_mul_f32 v117, s30, v117
    v_mul_f32 v118, s30, v118
    v_mul_f32 v119, s30, v119
    v_mul_f32 v120, s30, v120
    v_mul_f32 v121, s30, v121
    v_mul_f32 v122, s30, v122
    v_mul_f32 v123, s30, v123
    v_mul_f32 v124, s30, v124
    v_mul_f32 v125, s30, v125
    v_mul_f32 v126, s30, v126
    v_mul_f32 v127, s30, v127
P1_NOSC:
    v_cvt_pk_bf16_f32 v168, v64, v65
    v_cvt_pk_bf16_f32 v169, v66, v67
    v_cvt_pk_bf16_f32 v170, v68, v69
    v_cvt_pk_bf16_f32 v171, v70, v71
    s_nop 1
    v_permlane32_swap_b32 v168, v170
    v_permlane32_swap_b32 v169, v171
    v_cvt_pk_bf16_f32 v172, v96, v97
    v_cvt_pk_bf16_f32 v173, v98, v99
    v_cvt_pk_bf16_f32 v174, v100, v101
    v_cvt_pk_bf16_f32 v175, v102, v103
    s_nop 1
    v_permlane32_swap_b32 v172, v174
    v_permlane32_swap_b32 v173, v175
    v_cvt_pk_bf16_f32 v176, v72, v73
    v_cvt_pk_bf16_f32 v177, v74, v75
    v_cvt_pk_bf16_f32 v178, v76, v77
    v_cvt_pk_bf16_f32 v179, v78, v79
    s_nop 1
    v_permlane32_swap_b32 v176, v178
    v_permlane32_swap_b32 v177, v179
    v_cvt_pk_bf16_f32 v180, v104, v105
    v_cvt_pk_bf16_f32 v181, v106, v107
    v_cvt_pk_bf16_f32 v182, v108, v109
    v_cvt_pk_bf16_f32 v183, v110, v111
    s_nop 1
    v_permlane32_swap_b32 v180, v182
    v_permlane32_swap_b32 v181, v183
    v_cvt_pk_bf16_f32 v184, v80, v81
    v_cvt_pk_bf16_f32 v185, v82, v83
    v_cvt_pk_bf16_f32 v186, v84, v85
    v_cvt_pk_bf16_f32 v187, v86, v87
    s_nop 1
    v_permlane32_swap_b32 v184, v186
    v_permlane32_swap_b32 v185, v187
    v_cvt_pk_bf16_f32 v188, v112, v113
    v_cvt_pk_bf16_f32 v189, v114, v115
    v_cvt_pk_bf16_f32 v190, v116, v117
    v_cvt_pk_bf16_f32 v191, v118, v119
    s_nop 1
    v_permlane32_swap_b32 v188, v190
    v_permlane32_swap_b32 v189, v191
    v_cvt_pk_bf16_f32 v192, v88, v89
    v_cvt_pk_bf16_f32 v193, v90, v91
    v_cvt_pk_bf16_f32 v194, v92, v93
    v_cvt_pk_bf16_f32 v195, v94, v95
    s_nop 1
    v_permlane32_swap_b32 v192, v194
    v_permlane32_swap_b32 v193, v195
    v_cvt_pk_bf16_f32 v196, v120, v121
    v_cvt_pk_bf16_f32 v197, v122, v123
    v_cvt_pk_bf16_f32 v198, v124, v125
    v_cvt_pk_bf16_f32 v199, v126, v127
    s_nop 1
    v_permlane32_swap_b32 v196, v198
    v_permlane32_swap_b32 v197, v199
    s_branch P1_SIG
P1_VPATH:
    v_and_b32 v3, 31, v1
    s_lshl_b32 s30, s52, 7
    s_lshl_b32 s31, s18, 6
    s_add_u32 s30, s30, s31
    v_add_u32 v2, s30, v3
    v_lshrrev_b32 v4, 5, v1
    v_mul_u32_u24 v4, 320, v4
    v_add_u32 v4, 1280, v4
    v_add_u32 v5, 0, v2
    v_mul_u32_u24 v6, 3277, v5
    v_lshrrev_b32 v6, 16, v6
    v_mul_u32_u24 v7, 20, v6
    v_sub_u32 v5, v5, v7
    v_lshlrev_b32 v5, 4, v5
    v_mul_lo_u32 v6, v6, s53
    v_add3_u32 v56, v6, v5, v4
    v_add_u32 v200, s33, v56
    v_add_u32 v201, s33, v56
    v_add_u32 v201, 640, v201
    v_add_u32 v204, s34, v56
    v_add_u32 v205, s34, v56
    v_add_u32 v205, 640, v205
    v_add_u32 v5, 32, v2
    v_mul_u32_u24 v6, 3277, v5
    v_lshrrev_b32 v6, 16, v6
    v_mul_u32_u24 v7, 20, v6
    v_sub_u32 v5, v5, v7
    v_lshlrev_b32 v5, 4, v5
    v_mul_lo_u32 v6, v6, s53
    v_add3_u32 v56, v6, v5, v4
    v_add_u32 v202, s33, v56
    v_add_u32 v203, s33, v56
    v_add_u32 v203, 640, v203
    v_add_u32 v206, s34, v56
    v_add_u32 v207, s34, v56
    v_add_u32 v207, 640, v207
    s_waitcnt vmcnt(7)
    s_barrier
    ds_read_b128 v[24:27], v16 offset:0
    ds_read_b128 v[28:31], v16 offset:4096
    ds_read_b64_tr_b16 v[32:33], v20 offset:0
    ds_read_b64_tr_b16 v[34:35], v20 offset:1024
    ds_read_b64_tr_b16 v[36:37], v21 offset:0
    ds_read_b64_tr_b16 v[38:39], v21 offset:1024
    s_mov_b32 s26, 0
    s_mov_b32 s27, 0
    s_mov_b32 s48, 98304
.p2align 2
P1_LOOP_V:
    s_cmp_le_u32 s26, 7
    s_cselect_b64 vcc, -1, 0
    ds_read_b128 v[40:43], v17 offset:0
    ds_read_b128 v[44:47], v17 offset:4096
    ds_read_b64_tr_b16 v[48:49], v20 offset:4096
    ds_read_b64_tr_b16 v[50:51], v20 offset:5120
    ds_read_b64_tr_b16 v[52:53], v21 offset:4096
    ds_read_b64_tr_b16 v[54:55], v21 offset:5120
    s_waitcnt lgkmcnt(6)
    v_mfma_f32_32x32x16_bf16 v[64:79], v[24:27], v[32:35], v[64:79]
    s_cbranch_vccz P1_ND_V_7
    s_add_u32 m0, s48, s28
    s_nop 0
    buffer_load_dwordx4 v10, s[4:7], s24 offen offset:0  lds
P1_ND_V_7:
    v_mfma_f32_32x32x16_bf16 v[80:95], v[24:27], v[36:39], v[80:95]
    s_cbranch_vccz P1_ND_V_8
    buffer_load_dwordx4 v11, s[4:7], s24 offen offset:1024  lds
P1_ND_V_8:
    v_mfma_f32_32x32x16_bf16 v[96:111], v[28:31], v[32:35], v[96:111]
    v_mfma_f32_32x32x16_bf16 v[112:127], v[28:31], v[36:39], v[112:127]
    ds_read_b128 v[24:27], v18 offset:0
    ds_read_b128 v[28:31], v18 offset:4096
    ds_read_b64_tr_b16 v[32:33], v20 offset:8192
    ds_read_b64_tr_b16 v[34:35], v20 offset:9216
    ds_read_b64_tr_b16 v[36:37], v21 offset:8192
    ds_read_b64_tr_b16 v[38:39], v21 offset:9216
    s_waitcnt lgkmcnt(6)
    v_mfma_f32_32x32x16_bf16 v[64:79], v[40:43], v[48:51], v[64:79]
    s_cbranch_vccz P1_ND_V_9
    s_add_u32 m0, s48, s29
    s_nop 0
    buffer_load_dwordx4 v14, s[44:47], s25 offen offset:0  lds
P1_ND_V_9:
    v_mfma_f32_32x32x16_bf16 v[80:95], v[40:43], v[52:55], v[80:95]
    s_cbranch_vccz P1_ND_V_10
    buffer_load_dwordx4 v15, s[44:47], s25 offen offset:1024  lds
P1_ND_V_10:
    v_mfma_f32_32x32x16_bf16 v[96:111], v[44:47], v[48:51], v[96:111]
    v_mfma_f32_32x32x16_bf16 v[112:127], v[44:47], v[52:55], v[112:127]
    ds_read_b128 v[40:43], v19 offset:0
    ds_read_b128 v[44:47], v19 offset:4096
    ds_read_b64_tr_b16 v[48:49], v20 offset:12288
    ds_read_b64_tr_b16 v[50:51], v20 offset:13312
    ds_read_b64_tr_b16 v[52:53], v21 offset:12288
    ds_read_b64_tr_b16 v[54:55], v21 offset:13312
    s_waitcnt lgkmcnt(6)
    v_mfma_f32_32x32x16_bf16 v[64:79], v[24:27], v[32:35], v[64:79]
    s_cbranch_vccz P1_ND_V_11
    s_add_u32 m0, s48, s29
    s_add_u32 m0, m0, 16384
    s_nop 0
    buffer_load_dwordx4 v14, s[36:39], s25 offen offset:0  lds
P1_ND_V_11:
    v_mfma_f32_32x32x16_bf16 v[80:95], v[24:27], v[36:39], v[80:95]
    s_cbranch_vccz P1_ND_V_12
    buffer_load_dwordx4 v15, s[36:39], s25 offen offset:1024  lds
    s_add_u32 s24, s24, 128
    s_add_u32 s25, s25, 245760
P1_ND_V_12:
    v_mfma_f32_32x32x16_bf16 v[96:111], v[28:31], v[32:35], v[96:111]
    v_mfma_f32_32x32x16_bf16 v[112:127], v[28:31], v[36:39], v[112:127]
    s_cmp_eq_u32 s27, 98304
    s_mov_b32 s32, 49152
    s_cselect_b32 s32, 4294868992, s32
    v_add_u32 v16, s32, v16
    v_add_u32 v17, s32, v17
    v_add_u32 v18, s32, v18
    v_add_u32 v19, s32, v19
    v_add_u32 v20, s32, v20
    v_add_u32 v21, s32, v21
    s_cmp_eq_u32 s26, 9
    s_cbranch_scc1 P1_LAST_V
    s_cmp_ge_u32 s26, 8
    s_cbranch_scc1 P1_W0_V
    s_waitcnt vmcnt(6) lgkmcnt(0)
    s_branch P1_W1_V
P1_W0_V:
    s_waitcnt vmcnt(0) lgkmcnt(0)
P1_W1_V:
    s_barrier
    ds_read_b128 v[24:27], v16 offset:0
    ds_read_b128 v[28:31], v16 offset:4096
    ds_read_b64_tr_b16 v[32:33], v20 offset:0
    ds_read_b64_tr_b16 v[34:35], v20 offset:1024
    ds_read_b64_tr_b16 v[36:37], v21 offset:0
    ds_read_b64_tr_b16 v[38:39], v21 offset:1024
    v_mfma_f32_32x32x16_bf16 v[64:79], v[40:43], v[48:51], v[64:79]
    v_mfma_f32_32x32x16_bf16 v[80:95], v[40:43], v[52:55], v[80:95]
    v_mfma_f32_32x32x16_bf16 v[96:111], v[44:47], v[48:51], v[96:111]
    v_mfma_f32_32x32x16_bf16 v[112:127], v[44:47], v[52:55], v[112:127]
    s_mov_b32 s48, s27
    s_add_u32 s27, s27, s32
    s_add_u32 s26, s26, 1
    s_branch P1_LOOP_V
P1_LAST_V:
    s_waitcnt lgkmcnt(0)
    v_mfma_f32_32x32x16_bf16 v[64:79], v[40:43], v[48:51], v[64:79]
    v_mfma_f32_32x32x16_bf16 v[80:95], v[40:43], v[52:55], v[80:95]
    v_mfma_f32_32x32x16_bf16 v[96:111], v[44:47], v[48:51], v[96:111]
    v_mfma_f32_32x32x16_bf16 v[112:127], v[44:47], v[52:55], v[112:127]
    s_nop 12
    v_cvt_pk_bf16_f32 v168, v64, v65
    v_cvt_pk_bf16_f32 v169, v66, v67
    v_cvt_pk_bf16_f32 v170, v68, v69
    v_cvt_pk_bf16_f32 v171, v70, v71
    v_cvt_pk_bf16_f32 v172, v72, v73
    v_cvt_pk_bf16_f32 v173, v74, v75
    v_cvt_pk_bf16_f32 v174, v76, v77
    v_cvt_pk_bf16_f32 v175, v78, v79
    v_cvt_pk_bf16_f32 v176, v80, v81
    v_cvt_pk_bf16_f32 v177, v82, v83
    v_cvt_pk_bf16_f32 v178, v84, v85
    v_cvt_pk_bf16_f32 v179, v86, v87
    v_cvt_pk_bf16_f32 v180, v88, v89
    v_cvt_pk_bf16_f32 v181, v90, v91
    v_cvt_pk_bf16_f32 v182, v92, v93
    v_cvt_pk_bf16_f32 v183, v94, v95
    v_cvt_pk_bf16_f32 v184, v96, v97
    v_cvt_pk_bf16_f32 v185, v98, v99
    v_cvt_pk_bf16_f32 v186, v100, v101
    v_cvt_pk_bf16_f32 v187, v102, v103
    v_cvt_pk_bf16_f32 v188, v104, v105
    v_cvt_pk_bf16_f32 v189, v106, v107
    v_cvt_pk_bf16_f32 v190, v108, v109
    v_cvt_pk_bf16_f32 v191, v110, v111
    v_cvt_pk_bf16_f32 v192, v112, v113
    v_cvt_pk_bf16_f32 v193, v114, v115
    v_cvt_pk_bf16_f32 v194, v116, v117
    v_cvt_pk_bf16_f32 v195, v118, v119
    v_cvt_pk_bf16_f32 v196, v120, v121
    v_cvt_pk_bf16_f32 v197, v122, v123
    v_cvt_pk_bf16_f32 v198, v124, v125
    v_cvt_pk_bf16_f32 v199, v126, v127
P1_SIG:
    v_readfirstlane_b32 s62, v22
    s_nop 3
    s_sub_i32 m0, s62, s41
    s_abs_i32 m0, m0
    s_cmp_lt_u32 m0, 20000
    s_cselect_b32 s62, s62, 0
    s_cmp_eq_u32 s51, 0
    s_cbranch_scc0 P1_AW
    buffer_store_dwordx4 v[168:171], v200, s[8:11], 0 offen sc1
    buffer_store_dwordx4 v[172:175], v201, s[8:11], 0 offen sc1
    buffer_store_dwordx4 v[176:179], v202, s[8:11], 0 offen sc1
    buffer_store_dwordx4 v[180:183], v203, s[8:11], 0 offen sc1
    buffer_store_dwordx4 v[184:187], v204, s[8:11], 0 offen sc1
    buffer_store_dwordx4 v[188:191], v205, s[8:11], 0 offen sc1
    buffer_store_dwordx4 v[192:195], v206, s[8:11], 0 offen sc1
    buffer_store_dwordx4 v[196:199], v207, s[8:11], 0 offen sc1
    v_mov_b32 v200, 0x7f000000
    v_mov_b32 v201, 0x7f000000
    v_mov_b32 v202, 0x7f000000
    v_mov_b32 v203, 0x7f000000
    v_mov_b32 v204, 0x7f000000
    v_mov_b32 v205, 0x7f000000
    v_mov_b32 v206, 0x7f000000
    v_mov_b32 v207, 0x7f000000
P1_AW:
    s_lshl_b32 s30, s49, 4
    s_add_u32 s30, s30, s19
    s_lshl_b32 s30, s30, 6
    s_add_u32 s55, s30, 131072
    s_mul_i32 s30, s50, 10
    s_lshl_b32 s31, s52, 1
    s_add_u32 s30, s30, s31
    s_add_u32 s30, s30, s18
    s_lshl_b32 s30, s30, 4
    s_add_u32 s30, s30, s19
    s_lshl_b32 s30, s30, 1
    s_add_u32 s30, s30, s17
    s_lshl_b32 s30, s30, 6
    s_add_u32 s49, s30, 401408
    s_cmp_eq_u32 s51, 0
    s_cselect_b32 s49, 0, s49
    s_waitcnt vmcnt(0)
    s_barrier
    s_cmp_lg_u32 s16, 0
    s_cbranch_scc1 SIG_SKIP_13
    s_cmp_lg_u32 s62, 0
    s_cbranch_scc1 TAG_DONE_14
    s_mov_b32 s63, 0
    v_mov_b32 v6, 0
TAG_LOOP_15:
    buffer_load_dword v7, v6, s[12:15], 0 offen sc1
    s_waitcnt vmcnt(0)
    v_readfirstlane_b32 s62, v7
    s_nop 3
    s_sub_i32 m0, s62, s41
    s_abs_i32 m0, m0
    s_cmp_lt_u32 m0, 20000
    s_cselect_b32 s62, s62, 0
    s_add_u32 s63, s63, 1
    s_cmp_lg_u32 s62, 0
    s_cbranch_scc1 TAG_DONE_14
    s_sleep 4
    s_cmp_lt_u32 s63, 40000
    s_cbranch_scc1 TAG_LOOP_15
TAG_DONE_14:
    v_mul_u32_u24 v6, 33792, v1
    v_mov_b32 v7, s62
    s_mov_b64 exec, 0xFF
    buffer_store_dword v7, v6, s[8:11], s55 offen sc1
    s_mov_b64 exec, -1
SIG_SKIP_13:
    s_branch P2
P1_SPARE:
    s_mov_b32 s41, s34
    s_lshl_b32 s30, s30, 1
    s_add_u32 s30, s30, s31
    s_sub_u32 s19, s30, 30
    s_load_dwordx2 s[54:55], s[0:1], 16
    s_load_dwordx4 s[44:47], s[0:1], 40
    s_waitcnt lgkmcnt(0)
    s_mov_b32 s4, s36
    s_mov_b32 s5, s37
    s_mov_b32 s6, 2621440
    s_mov_b32 s7, 0x20000
    s_mov_b32 s24, s46
    s_mov_b32 s25, s47
    s_mov_b32 s26, 1280
    s_mov_b32 s27, 0x20000
    s_mul_i32 s30, s16, 5120
    s_mul_i32 s33, s16, 320
    v_add_u32 v2, s33, v1
    v_mul_u32_u24 v3, 52429, v2
    v_lshrrev_b32 v3, 22, v3
    v_mul_u32_u24 v4, 80, v3
    v_sub_u32 v4, v2, v4
    v_mov_b32 v140, v3
    v_lshlrev_b32 v146, 4, v4
    v_add_u32 v2, s33, v1
    v_add_u32 v2, 64, v2
    v_mul_u32_u24 v3, 52429, v2
    v_lshrrev_b32 v3, 22, v3
    v_mul_u32_u24 v4, 80, v3
    v_sub_u32 v4, v2, v4
    v_mov_b32 v141, v3
    v_lshlrev_b32 v147, 4, v4
    v_add_u32 v2, s33, v1
    v_add_u32 v2, 128, v2
    v_mul_u32_u24 v3, 52429, v2
    v_lshrrev_b32 v3, 22, v3
    v_mul_u32_u24 v4, 80, v3
    v_sub_u32 v4, v2, v4
    v_mov_b32 v142, v3
    v_lshlrev_b32 v148, 4, v4
    v_add_u32 v2, s33, v1
    v_add_u32 v2, 192, v2
    v_mul_u32_u24 v3, 52429, v2
    v_lshrrev_b32 v3, 22, v3
    v_mul_u32_u24 v4, 80, v3
    v_sub_u32 v4, v2, v4
    v_mov_b32 v143, v3
    v_lshlrev_b32 v149, 4, v4
    v_add_u32 v2, s33, v1
    v_add_u32 v2, 256, v2
    v_mul_u32_u24 v3, 52429, v2
    v_lshrrev_b32 v3, 22, v3
    v_mul_u32_u24 v4, 80, v3
    v_sub_u32 v4, v2, v4
    v_mov_b32 v144, v3
    v_lshlrev_b32 v150, 4, v4
    s_add_u32 s31, s19, 0
    s_cmp_ge_u32 s31, 20
    s_cselect_b32 s48, s44, s54
    s_cselect_b32 s49, s45, s55
    s_cselect_b32 s33, 20, 0
    s_sub_u32 s33, s31, s33
    s_lshl_b32 s33, s33, 5
    s_mov_b32 s50, 819200
    s_mov_b32 s51, 0x20000
    v_add_u32 v2, s33, v140
    v_mul_u32_u24 v3, 52429, v2
    v_lshrrev_b32 v3, 21, v3
    v_mul_u32_u24 v4, 40, v3
    v_sub_u32 v5, v2, v4
    v_add_u32 v6, 16, v5
    v_subrev_u32 v7, 4, v5
    v_cmp_gt_u32 vcc, 24, v5
    s_nop 1
    v_cndmask_b32 v6, v7, v6, vcc
    v_cmp_gt_u32 vcc, 20, v5
    s_nop 1
    v_cndmask_b32 v6, v6, v5, vcc
    v_add_u32 v6, v6, v4
    v_mul_u32_u24 v6, 1280, v6
    v_add_u32 v6, v6, v146
    s_add_u32 m0, s30, 0
    s_nop 0
    buffer_load_dwordx4 v6, s[48:51], 0 offen lds
    v_add_u32 v2, s33, v141
    v_mul_u32_u24 v3, 52429, v2
    v_lshrrev_b32 v3, 21, v3
    v_mul_u32_u24 v4, 40, v3
    v_sub_u32 v5, v2, v4
    v_add_u32 v6, 16, v5
    v_subrev_u32 v7, 4, v5
    v_cmp_gt_u32 vcc, 24, v5
    s_nop 1
    v_cndmask_b32 v6, v7, v6, vcc
    v_cmp_gt_u32 vcc, 20, v5
    s_nop 1
    v_cndmask_b32 v6, v6, v5, vcc
    v_add_u32 v6, v6, v4
    v_mul_u32_u24 v6, 1280, v6
    v_add_u32 v6, v6, v147
    s_add_u32 m0, s30, 1024
    s_nop 0
    buffer_load_dwordx4 v6, s[48:51], 0 offen lds
    v_add_u32 v2, s33, v142
    v_mul_u32_u24 v3, 52429, v2
    v_lshrrev_b32 v3, 21, v3
    v_mul_u32_u24 v4, 40, v3
    v_sub_u32 v5, v2, v4
    v_add_u32 v6, 16, v5
    v_subrev_u32 v7, 4, v5
    v_cmp_gt_u32 vcc, 24, v5
    s_nop 1
    v_cndmask_b32 v6, v7, v6, vcc
    v_cmp_gt_u32 vcc, 20, v5
    s_nop 1
    v_cndmask_b32 v6, v6, v5, vcc
    v_add_u32 v6, v6, v4
    v_mul_u32_u24 v6, 1280, v6
    v_add_u32 v6, v6, v148
    s_add_u32 m0, s30, 2048
    s_nop 0
    buffer_load_dwordx4 v6, s[48:51], 0 offen lds
    v_add_u32 v2, s33, v143
    v_mul_u32_u24 v3, 52429, v2
    v_lshrrev_b32 v3, 21, v3
    v_mul_u32_u24 v4, 40, v3
    v_sub_u32 v5, v2, v4
    v_add_u32 v6, 16, v5
    v_subrev_u32 v7, 4, v5
    v_cmp_gt_u32 vcc, 24, v5
    s_nop 1
    v_cndmask_b32 v6, v7, v6, vcc
    v_cmp_gt_u32 vcc, 20, v5
    s_nop 1
    v_cndmask_b32 v6, v6, v5, vcc
    v_add_u32 v6, v6, v4
    v_mul_u32_u24 v6, 1280, v6
    v_add_u32 v6, v6, v149
    s_add_u32 m0, s30, 3072
    s_nop 0
    buffer_load_dwordx4 v6, s[48:51], 0 offen lds
    v_add_u32 v2, s33, v144
    v_mul_u32_u24 v3, 52429, v2
    v_lshrrev_b32 v3, 21, v3
    v_mul_u32_u24 v4, 40, v3
    v_sub_u32 v5, v2, v4
    v_add_u32 v6, 16, v5
    v_subrev_u32 v7, 4, v5
    v_cmp_gt_u32 vcc, 24, v5
    s_nop 1
    v_cndmask_b32 v6, v7, v6, vcc
    v_cmp_gt_u32 vcc, 20, v5
    s_nop 1
    v_cndmask_b32 v6, v6, v5, vcc
    v_add_u32 v6, v6, v4
    v_mul_u32_u24 v6, 1280, v6
    v_add_u32 v6, v6, v150
    s_add_u32 m0, s30, 4096
    s_nop 0
    buffer_load_dwordx4 v6, s[48:51], 0 offen lds
    s_add_u32 s31, s19, 16
    s_cmp_ge_u32 s31, 20
    s_cselect_b32 s48, s44, s54
    s_cselect_b32 s49, s45, s55
    s_cselect_b32 s33, 20, 0
    s_sub_u32 s33, s31, s33
    s_lshl_b32 s33, s33, 5
    s_mov_b32 s50, 819200
    s_mov_b32 s51, 0x20000
    v_add_u32 v2, s33, v140
    v_mul_u32_u24 v3, 52429, v2
    v_lshrrev_b32 v3, 21, v3
    v_mul_u32_u24 v4, 40, v3
    v_sub_u32 v5, v2, v4
    v_add_u32 v6, 16, v5
    v_subrev_u32 v7, 4, v5
    v_cmp_gt_u32 vcc, 24, v5
    s_nop 1
    v_cndmask_b32 v6, v7, v6, vcc
    v_cmp_gt_u32 vcc, 20, v5
    s_nop 1
    v_cndmask_b32 v6, v6, v5, vcc
    v_add_u32 v6, v6, v4
    v_mul_u32_u24 v6, 1280, v6
    v_add_u32 v6, v6, v146
    s_add_u32 m0, s30, 40960
    s_nop 0
    buffer_load_dwordx4 v6, s[48:51], 0 offen lds
    v_add_u32 v2, s33, v141
    v_mul_u32_u24 v3, 52429, v2
    v_lshrrev_b32 v3, 21, v3
    v_mul_u32_u24 v4, 40, v3
    v_sub_u32 v5, v2, v4
    v_add_u32 v6, 16, v5
    v_subrev_u32 v7, 4, v5
    v_cmp_gt_u32 vcc, 24, v5
    s_nop 1
    v_cndmask_b32 v6, v7, v6, vcc
    v_cmp_gt_u32 vcc, 20, v5
    s_nop 1
    v_cndmask_b32 v6, v6, v5, vcc
    v_add_u32 v6, v6, v4
    v_mul_u32_u24 v6, 1280, v6
    v_add_u32 v6, v6, v147
    s_add_u32 m0, s30, 41984
    s_nop 0
    buffer_load_dwordx4 v6, s[48:51], 0 offen lds
    v_add_u32 v2, s33, v142
    v_mul_u32_u24 v3, 52429, v2
    v_lshrrev_b32 v3, 21, v3
    v_mul_u32_u24 v4, 40, v3
    v_sub_u32 v5, v2, v4
    v_add_u32 v6, 16, v5
    v_subrev_u32 v7, 4, v5
    v_cmp_gt_u32 vcc, 24, v5
    s_nop 1
    v_cndmask_b32 v6, v7, v6, vcc
    v_cmp_gt_u32 vcc, 20, v5
    s_nop 1
    v_cndmask_b32 v6, v6, v5, vcc
    v_add_u32 v6, v6, v4
    v_mul_u32_u24 v6, 1280, v6
    v_add_u32 v6, v6, v148
    s_add_u32 m0, s30, 43008
    s_nop 0
    buffer_load_dwordx4 v6, s[48:51], 0 offen lds
    v_add_u32 v2, s33, v143
    v_mul_u32_u24 v3, 52429, v2
    v_lshrrev_b32 v3, 21, v3
    v_mul_u32_u24 v4, 40, v3
    v_sub_u32 v5, v2, v4
    v_add_u32 v6, 16, v5
    v_subrev_u32 v7, 4, v5
    v_cmp_gt_u32 vcc, 24, v5
    s_nop 1
    v_cndmask_b32 v6, v7, v6, vcc
    v_cmp_gt_u32 vcc, 20, v5
    s_nop 1
    v_cndmask_b32 v6, v6, v5, vcc
    v_add_u32 v6, v6, v4
    v_mul_u32_u24 v6, 1280, v6
    v_add_u32 v6, v6, v149
    s_add_u32 m0, s30, 44032
    s_nop 0
    buffer_load_dwordx4 v6, s[48:51], 0 offen lds
    v_add_u32 v2, s33, v144
    v_mul_u32_u24 v3, 52429, v2
    v_lshrrev_b32 v3, 21, v3
    v_mul_u32_u24 v4, 40, v3
    v_sub_u32 v5, v2, v4
    v_add_u32 v6, 16, v5
    v_subrev_u32 v7, 4, v5
    v_cmp_gt_u32 vcc, 24, v5
    s_nop 1
    v_cndmask_b32 v6, v7, v6, vcc
    v_cmp_gt_u32 vcc, 20, v5
    s_nop 1
    v_cndmask_b32 v6, v6, v5, vcc
    v_add_u32 v6, v6, v4
    v_mul_u32_u24 v6, 1280, v6
    v_add_u32 v6, v6, v150
    s_add_u32 m0, s30, 45056
    s_nop 0
    buffer_load_dwordx4 v6, s[48:51], 0 offen lds
    s_add_u32 s31, s19, 32
    s_cmp_ge_u32 s31, 40
    s_cbranch_scc1 P1_SL2_SKIP
    s_cmp_ge_u32 s31, 20
    s_cselect_b32 s48, s44, s54
    s_cselect_b32 s49, s45, s55
    s_cselect_b32 s33, 20, 0
    s_sub_u32 s33, s31, s33
    s_lshl_b32 s33, s33, 5
    s_mov_b32 s50, 819200
    s_mov_b32 s51, 0x20000
    v_add_u32 v2, s33, v140
    v_mul_u32_u24 v3, 52429, v2
    v_lshrrev_b32 v3, 21, v3
    v_mul_u32_u24 v4, 40, v3
    v_sub_u32 v5, v2, v4
    v_add_u32 v6, 16, v5
    v_subrev_u32 v7, 4, v5
    v_cmp_gt_u32 vcc, 24, v5
    s_nop 1
    v_cndmask_b32 v6, v7, v6, vcc
    v_cmp_gt_u32 vcc, 20, v5
    s_nop 1
    v_cndmask_b32 v6, v6, v5, vcc
    v_add_u32 v6, v6, v4
    v_mul_u32_u24 v6, 1280, v6
    v_add_u32 v6, v6, v146
    s_add_u32 m0, s30, 81920
    s_nop 0
    buffer_load_dwordx4 v6, s[48:51], 0 offen lds
    v_add_u32 v2, s33, v141
    v_mul_u32_u24 v3, 52429, v2
    v_lshrrev_b32 v3, 21, v3
    v_mul_u32_u24 v4, 40, v3
    v_sub_u32 v5, v2, v4
    v_add_u32 v6, 16, v5
    v_subrev_u32 v7, 4, v5
    v_cmp_gt_u32 vcc, 24, v5
    s_nop 1
    v_cndmask_b32 v6, v7, v6, vcc
    v_cmp_gt_u32 vcc, 20, v5
    s_nop 1
    v_cndmask_b32 v6, v6, v5, vcc
    v_add_u32 v6, v6, v4
    v_mul_u32_u24 v6, 1280, v6
    v_add_u32 v6, v6, v147
    s_add_u32 m0, s30, 82944
    s_nop 0
    buffer_load_dwordx4 v6, s[48:51], 0 offen lds
    v_add_u32 v2, s33, v142
    v_mul_u32_u24 v3, 52429, v2
    v_lshrrev_b32 v3, 21, v3
    v_mul_u32_u24 v4, 40, v3
    v_sub_u32 v5, v2, v4
    v_add_u32 v6, 16, v5
    v_subrev_u32 v7, 4, v5
    v_cmp_gt_u32 vcc, 24, v5
    s_nop 1
    v_cndmask_b32 v6, v7, v6, vcc
    v_cmp_gt_u32 vcc, 20, v5
    s_nop 1
    v_cndmask_b32 v6, v6, v5, vcc
    v_add_u32 v6, v6, v4
    v_mul_u32_u24 v6, 1280, v6
    v_add_u32 v6, v6, v148
    s_add_u32 m0, s30, 83968
    s_nop 0
    buffer_load_dwordx4 v6, s[48:51], 0 offen lds
    v_add_u32 v2, s33, v143
    v_mul_u32_u24 v3, 52429, v2
    v_lshrrev_b32 v3, 21, v3
    v_mul_u32_u24 v4, 40, v3
    v_sub_u32 v5, v2, v4
    v_add_u32 v6, 16, v5
    v_subrev_u32 v7, 4, v5
    v_cmp_gt_u32 vcc, 24, v5
    s_nop 1
    v_cndmask_b32 v6, v7, v6, vcc
    v_cmp_gt_u32 vcc, 20, v5
    s_nop 1
    v_cndmask_b32 v6, v6, v5, vcc
    v_add_u32 v6, v6, v4
    v_mul_u32_u24 v6, 1280, v6
    v_add_u32 v6, v6, v149
    s_add_u32 m0, s30, 84992
    s_nop 0
    buffer_load_dwordx4 v6, s[48:51], 0 offen lds
    v_add_u32 v2, s33, v144
    v_mul_u32_u24 v3, 52429, v2
    v_lshrrev_b32 v3, 21, v3
    v_mul_u32_u24 v4, 40, v3
    v_sub_u32 v5, v2, v4
    v_add_u32 v6, 16, v5
    v_subrev_u32 v7, 4, v5
    v_cmp_gt_u32 vcc, 24, v5
    s_nop 1
    v_cndmask_b32 v6, v7, v6, vcc
    v_cmp_gt_u32 vcc, 20, v5
    s_nop 1
    v_cndmask_b32 v6, v6, v5, vcc
    v_add_u32 v6, v6, v4
    v_mul_u32_u24 v6, 1280, v6
    v_add_u32 v6, v6, v150
    s_add_u32 m0, s30, 86016
    s_nop 0
    buffer_load_dwordx4 v6, s[48:51], 0 offen lds
P1_SL2_SKIP:
    v_lshrrev_b32 v3, 3, v1
    s_lshl_b32 s30, s19, 7
    s_lshl_b32 s31, s16, 4
    s_add_u32 s30, s30, s31
    v_add_u32 v3, s30, v3
    v_and_b32 v4, 7, v1
    v_lshlrev_b32 v4, 4, v4
    v_mul_u32_u24 v5, 1280, v3
    v_add_u32 v5, v5, v4
    v_add_u32 v6, 10240, v5
    buffer_load_dwordx4 v[16:19], v4, s[24:27], 0 offen offset:0
    buffer_load_dwordx4 v[20:23], v4, s[24:27], 0 offen offset:128
    buffer_load_dwordx4 v[24:27], v4, s[24:27], 0 offen offset:256
    buffer_load_dwordx4 v[28:31], v4, s[24:27], 0 offen offset:384
    buffer_load_dwordx4 v[32:35], v4, s[24:27], 0 offen offset:512
    buffer_load_dwordx4 v[36:39], v4, s[24:27], 0 offen offset:640
    buffer_load_dwordx4 v[40:43], v4, s[24:27], 0 offen offset:768
    buffer_load_dwordx4 v[44:47], v4, s[24:27], 0 offen offset:896
    buffer_load_dwordx4 v[48:51], v4, s[24:27], 0 offen offset:1024
    buffer_load_dwordx4 v[52:55], v4, s[24:27], 0 offen offset:1152
    buffer_load_dwordx4 v[56:59], v5, s[4:7], 0 offen offset:0
    buffer_load_dwordx4 v[60:63], v5, s[4:7], 0 offen offset:128
    buffer_load_dwordx4 v[64:67], v5, s[4:7], 0 offen offset:256
    buffer_load_dwordx4 v[68:71], v5, s[4:7], 0 offen offset:384
    buffer_load_dwordx4 v[72:75], v5, s[4:7], 0 offen offset:512
    buffer_load_dwordx4 v[76:79], v5, s[4:7], 0 offen offset:640
    buffer_load_dwordx4 v[80:83], v5, s[4:7], 0 offen offset:768
    buffer_load_dwordx4 v[84:87], v5, s[4:7], 0 offen offset:896
    buffer_load_dwordx4 v[88:91], v5, s[4:7], 0 offen offset:1024
    buffer_load_dwordx4 v[92:95], v5, s[4:7], 0 offen offset:1152
    buffer_load_dwordx4 v[96:99], v6, s[4:7], 0 offen offset:0
    buffer_load_dwordx4 v[100:103], v6, s[4:7], 0 offen offset:128
    buffer_load_dwordx4 v[104:107], v6, s[4:7], 0 offen offset:256
    buffer_load_dwordx4 v[108:111], v6, s[4:7], 0 offen offset:384
    buffer_load_dwordx4 v[112:115], v6, s[4:7], 0 offen offset:512
    buffer_load_dwordx4 v[116:119], v6, s[4:7], 0 offen offset:640
    buffer_load_dwordx4 v[120:123], v6, s[4:7], 0 offen offset:768
    buffer_load_dwordx4 v[124:127], v6, s[4:7], 0 offen offset:896
    buffer_load_dwordx4 v[128:131], v6, s[4:7], 0 offen offset:1024
    buffer_load_dwordx4 v[132:135], v6, s[4:7], 0 offen offset:1152
    s_waitcnt vmcnt(0)
    v_mov_b32 v8, 0
    v_dot2_f32_bf16 v8, v56, v16, v8
    v_dot2_f32_bf16 v8, v57, v17, v8
    v_dot2_f32_bf16 v8, v58, v18, v8
    v_dot2_f32_bf16 v8, v59, v19, v8
    v_dot2_f32_bf16 v8, v60, v20, v8
    v_dot2_f32_bf16 v8, v61, v21, v8
    v_dot2_f32_bf16 v8, v62, v22, v8
    v_dot2_f32_bf16 v8, v63, v23, v8
    v_dot2_f32_bf16 v8, v64, v24, v8
    v_dot2_f32_bf16 v8, v65, v25, v8
    v_dot2_f32_bf16 v8, v66, v26, v8
    v_dot2_f32_bf16 v8, v67, v27, v8
    v_dot2_f32_bf16 v8, v68, v28, v8
    v_dot2_f32_bf16 v8, v69, v29, v8
    v_dot2_f32_bf16 v8, v70, v30, v8
    v_dot2_f32_bf16 v8, v71, v31, v8
    v_dot2_f32_bf16 v8, v72, v32, v8
    v_dot2_f32_bf16 v8, v73, v33, v8
    v_dot2_f32_bf16 v8, v74, v34, v8
    v_dot2_f32_bf16 v8, v75, v35, v8
    v_dot2_f32_bf16 v8, v76, v36, v8
    v_dot2_f32_bf16 v8, v77, v37, v8
    v_dot2_f32_bf16 v8, v78, v38, v8
    v_dot2_f32_bf16 v8, v79, v39, v8
    v_dot2_f32_bf16 v8, v80, v40, v8
    v_dot2_f32_bf16 v8, v81, v41, v8
    v_dot2_f32_bf16 v8, v82, v42, v8
    v_dot2_f32_bf16 v8, v83, v43, v8
    v_dot2_f32_bf16 v8, v84, v44, v8
    v_dot2_f32_bf16 v8, v85, v45, v8
    v_dot2_f32_bf16 v8, v86, v46, v8
    v_dot2_f32_bf16 v8, v87, v47, v8
    v_dot2_f32_bf16 v8, v88, v48, v8
    v_dot2_f32_bf16 v8, v89, v49, v8
    v_dot2_f32_bf16 v8, v90, v50, v8
    v_dot2_f32_bf16 v8, v91, v51, v8
    v_dot2_f32_bf16 v8, v92, v52, v8
    v_dot2_f32_bf16 v8, v93, v53, v8
    v_dot2_f32_bf16 v8, v94, v54, v8
    v_dot2_f32_bf16 v8, v95, v55, v8
    v_mov_b32 v9, 0
    v_dot2_f32_bf16 v9, v96, v16, v9
    v_dot2_f32_bf16 v9, v97, v17, v9
    v_dot2_f32_bf16 v9, v98, v18, v9
    v_dot2_f32_bf16 v9, v99, v19, v9
    v_dot2_f32_bf16 v9, v100, v20, v9
    v_dot2_f32_bf16 v9, v101, v21, v9
    v_dot2_f32_bf16 v9, v102, v22, v9
    v_dot2_f32_bf16 v9, v103, v23, v9
    v_dot2_f32_bf16 v9, v104, v24, v9
    v_dot2_f32_bf16 v9, v105, v25, v9
    v_dot2_f32_bf16 v9, v106, v26, v9
    v_dot2_f32_bf16 v9, v107, v27, v9
    v_dot2_f32_bf16 v9, v108, v28, v9
    v_dot2_f32_bf16 v9, v109, v29, v9
    v_dot2_f32_bf16 v9, v110, v30, v9
    v_dot2_f32_bf16 v9, v111, v31, v9
    v_dot2_f32_bf16 v9, v112, v32, v9
    v_dot2_f32_bf16 v9, v113, v33, v9
    v_dot2_f32_bf16 v9, v114, v34, v9
    v_dot2_f32_bf16 v9, v115, v35, v9
    v_dot2_f32_bf16 v9, v116, v36, v9
    v_dot2_f32_bf16 v9, v117, v37, v9
    v_dot2_f32_bf16 v9, v118, v38, v9
    v_dot2_f32_bf16 v9, v119, v39, v9
    v_dot2_f32_bf16 v9, v120, v40, v9
    v_dot2_f32_bf16 v9, v121, v41, v9
    v_dot2_f32_bf16 v9, v122, v42, v9
    v_dot2_f32_bf16 v9, v123, v43, v9
    v_dot2_f32_bf16 v9, v124, v44, v9
    v_dot2_f32_bf16 v9, v125, v45, v9
    v_dot2_f32_bf16 v9, v126, v46, v9
    v_dot2_f32_bf16 v9, v127, v47, v9
    v_dot2_f32_bf16 v9, v128, v48, v9
    v_dot2_f32_bf16 v9, v129, v49, v9
    v_dot2_f32_bf16 v9, v130, v50, v9
    v_dot2_f32_bf16 v9, v131, v51, v9
    v_dot2_f32_bf16 v9, v132, v52, v9
    v_dot2_f32_bf16 v9, v133, v53, v9
    v_dot2_f32_bf16 v9, v134, v54, v9
    v_dot2_f32_bf16 v9, v135, v55, v9
    s_nop 1
    v_add_f32_dpp v8, v8, v8 quad_perm:[1,0,3,2] row_mask:0xf bank_mask:0xf
    s_nop 1
    v_add_f32_dpp v8, v8, v8 quad_perm:[2,3,0,1] row_mask:0xf bank_mask:0xf
    s_nop 1
    v_add_f32_dpp v8, v8, v8 row_half_mirror row_mask:0xf bank_mask:0xf
    s_nop 1
    v_cvt_pk_bf16_f32 v8, v8, 0
    v_lshlrev_b32 v8, 16, v8
    v_mul_f32 v10, 3216550459, v8
    v_exp_f32 v10, v10
    s_nop 0
    v_add_f32 v10, 1.0, v10
    v_rcp_f32 v10, v10
    s_nop 0
    v_cvt_pk_bf16_f32 v10, v10, 0
    v_lshlrev_b32 v10, 16, v10
    v_sub_f32 v11, 1.0, v10
    v_cvt_pk_bf16_f32 v11, v11, 0
    v_lshlrev_b32 v11, 16, v11
    v_add_u32 v12, 0, v3
    v_lshlrev_b32 v12, 2, v12
    v_and_b32 v13, 7, v1
    v_cmp_eq_u32 vcc, 0, v13
    s_and_saveexec_b64 s[52:53], vcc
    buffer_store_dword v10, v12, s[8:11], 0 offen sc1
    v_add_u32 v12, 8192, v12
    buffer_store_dword v11, v12, s[8:11], 0 offen sc1
    s_mov_b64 exec, s[52:53]
    v_add_f32_dpp v9, v9, v9 quad_perm:[1,0,3,2] row_mask:0xf bank_mask:0xf
    s_nop 1
    v_add_f32_dpp v9, v9, v9 quad_perm:[2,3,0,1] row_mask:0xf bank_mask:0xf
    s_nop 1
    v_add_f32_dpp v9, v9, v9 row_half_mirror row_mask:0xf bank_mask:0xf
    s_nop 1
    v_cvt_pk_bf16_f32 v9, v9, 0
    v_lshlrev_b32 v9, 16, v9
    v_mul_f32 v10, 3216550459, v9
    v_exp_f32 v10, v10
    s_nop 0
    v_add_f32 v10, 1.0, v10
    v_rcp_f32 v10, v10
    s_nop 0
    v_cvt_pk_bf16_f32 v10, v10, 0
    v_lshlrev_b32 v10, 16, v10
    v_sub_f32 v11, 1.0, v10
    v_cvt_pk_bf16_f32 v11, v11, 0
    v_lshlrev_b32 v11, 16, v11
    v_add_u32 v12, 8, v3
    v_lshlrev_b32 v12, 2, v12
    v_and_b32 v13, 7, v1
    v_cmp_eq_u32 vcc, 0, v13
    s_and_saveexec_b64 s[52:53], vcc
    buffer_store_dword v10, v12, s[8:11], 0 offen sc1
    v_add_u32 v12, 8192, v12
    buffer_store_dword v11, v12, s[8:11], 0 offen sc1
    s_mov_b64 exec, s[52:53]
    s_lshl_b32 s30, s19, 6
    s_add_u32 s30, s30, 146432
    s_waitcnt vmcnt(0)
    s_barrier
    s_cmp_lg_u32 s16, 0
    s_cbranch_scc1 SIG_SKIP_16
    s_cmp_lg_u32 s62, 0
    s_cbranch_scc1 TAG_DONE_17
    s_mov_b32 s63, 0
    v_mov_b32 v6, 0
TAG_LOOP_18:
    buffer_load_dword v7, v6, s[12:15], 0 offen sc1
    s_waitcnt vmcnt(0)
    v_readfirstlane_b32 s62, v7
    s_nop 3
    s_sub_i32 m0, s62, s41
    s_abs_i32 m0, m0
    s_cmp_lt_u32 m0, 20000
    s_cselect_b32 s62, s62, 0
    s_add_u32 s63, s63, 1
    s_cmp_lg_u32 s62, 0
    s_cbranch_scc1 TAG_DONE_17
    s_sleep 4
    s_cmp_lt_u32 s63, 40000
    s_cbranch_scc1 TAG_LOOP_18
TAG_DONE_17:
    v_mul_u32_u24 v6, 33792, v1
    v_mov_b32 v7, s62
    s_mov_b64 exec, 0xFF
    buffer_store_dword v7, v6, s[8:11], s30 offen sc1
    s_mov_b64 exec, -1
SIG_SKIP_16:
    v_lshrrev_b32 v2, 4, v1
    v_lshlrev_b32 v2, 3, v2
    v_bfe_u32 v3, v1, 2, 2
    v_add_u32 v2, v2, v3
    v_mul_u32_u24 v2, 1280, v2
    v_and_b32 v3, 3, v1
    v_lshlrev_b32 v3, 3, v3
    v_add_u32 v2, v2, v3
    s_mul_i32 s30, s16, 160
    v_add_u32 v2, s30, v2
    v_lshlrev_b32 v4, 4, v1
    s_add_u32 s31, s19, 0
    ds_read_b64_tr_b16 v[16:17], v2 offset:0
    ds_read_b64_tr_b16 v[18:19], v2 offset:5120
    ds_read_b64_tr_b16 v[20:21], v2 offset:32
    ds_read_b64_tr_b16 v[22:23], v2 offset:5152
    ds_read_b64_tr_b16 v[24:25], v2 offset:64
    ds_read_b64_tr_b16 v[26:27], v2 offset:5184
    ds_read_b64_tr_b16 v[28:29], v2 offset:96
    ds_read_b64_tr_b16 v[30:31], v2 offset:5216
    ds_read_b64_tr_b16 v[32:33], v2 offset:128
    ds_read_b64_tr_b16 v[34:35], v2 offset:5248
    v_add_u32 v2, 40960, v2
    s_mul_i32 s33, s16, 200
    s_add_u32 s33, s33, s31
    s_lshl_b32 s33, s33, 10
    s_add_u32 s33, s33, 22282240
    s_waitcnt lgkmcnt(0)
    buffer_store_dwordx4 v[16:19], v4, s[8:11], s33 offen sc1
    s_add_u32 s33, s33, 40960
    buffer_store_dwordx4 v[20:23], v4, s[8:11], s33 offen sc1
    s_add_u32 s33, s33, 40960
    buffer_store_dwordx4 v[24:27], v4, s[8:11], s33 offen sc1
    s_add_u32 s33, s33, 40960
    buffer_store_dwordx4 v[28:31], v4, s[8:11], s33 offen sc1
    s_add_u32 s33, s33, 40960
    buffer_store_dwordx4 v[32:35], v4, s[8:11], s33 offen sc1
    s_waitcnt vmcnt(0)
    s_add_u32 s31, s19, 16
    ds_read_b64_tr_b16 v[16:17], v2 offset:0
    ds_read_b64_tr_b16 v[18:19], v2 offset:5120
    ds_read_b64_tr_b16 v[20:21], v2 offset:32
    ds_read_b64_tr_b16 v[22:23], v2 offset:5152
    ds_read_b64_tr_b16 v[24:25], v2 offset:64
    ds_read_b64_tr_b16 v[26:27], v2 offset:5184
    ds_read_b64_tr_b16 v[28:29], v2 offset:96
    ds_read_b64_tr_b16 v[30:31], v2 offset:5216
    ds_read_b64_tr_b16 v[32:33], v2 offset:128
    ds_read_b64_tr_b16 v[34:35], v2 offset:5248
    v_add_u32 v2, 40960, v2
    s_mul_i32 s33, s16, 200
    s_add_u32 s33, s33, s31
    s_lshl_b32 s33, s33, 10
    s_add_u32 s33, s33, 22282240
    s_waitcnt lgkmcnt(0)
    buffer_store_dwordx4 v[16:19], v4, s[8:11], s33 offen sc1
    s_add_u32 s33, s33, 40960
    buffer_store_dwordx4 v[20:23], v4, s[8:11], s33 offen sc1
    s_add_u32 s33, s33, 40960
    buffer_store_dwordx4 v[24:27], v4, s[8:11], s33 offen sc1
    s_add_u32 s33, s33, 40960
    buffer_store_dwordx4 v[28:31], v4, s[8:11], s33 offen sc1
    s_add_u32 s33, s33, 40960
    buffer_store_dwordx4 v[32:35], v4, s[8:11], s33 offen sc1
    s_waitcnt vmcnt(0)
    s_add_u32 s31, s19, 32
    s_cmp_ge_u32 s31, 40
    s_cbranch_scc1 P1_WODONE
    ds_read_b64_tr_b16 v[16:17], v2 offset:0
    ds_read_b64_tr_b16 v[18:19], v2 offset:5120
    ds_read_b64_tr_b16 v[20:21], v2 offset:32
    ds_read_b64_tr_b16 v[22:23], v2 offset:5152
    ds_read_b64_tr_b16 v[24:25], v2 offset:64
    ds_read_b64_tr_b16 v[26:27], v2 offset:5184
    ds_read_b64_tr_b16 v[28:29], v2 offset:96
    ds_read_b64_tr_b16 v[30:31], v2 offset:5216
    ds_read_b64_tr_b16 v[32:33], v2 offset:128
    ds_read_b64_tr_b16 v[34:35], v2 offset:5248
    v_add_u32 v2, 40960, v2
    s_mul_i32 s33, s16, 200
    s_add_u32 s33, s33, s31
    s_lshl_b32 s33, s33, 10
    s_add_u32 s33, s33, 22282240
    s_waitcnt lgkmcnt(0)
    buffer_store_dwordx4 v[16:19], v4, s[8:11], s33 offen sc1
    s_add_u32 s33, s33, 40960
    buffer_store_dwordx4 v[20:23], v4, s[8:11], s33 offen sc1
    s_add_u32 s33, s33, 40960
    buffer_store_dwordx4 v[24:27], v4, s[8:11], s33 offen sc1
    s_add_u32 s33, s33, 40960
    buffer_store_dwordx4 v[28:31], v4, s[8:11], s33 offen sc1
    s_add_u32 s33, s33, 40960
    buffer_store_dwordx4 v[32:35], v4, s[8:11], s33 offen sc1
    s_waitcnt vmcnt(0)
P1_WODONE:
    s_lshl_b32 s30, s19, 6
    s_add_u32 s30, s30, 147456
    s_waitcnt vmcnt(0)
    s_barrier
    s_cmp_lg_u32 s16, 0
    s_cbranch_scc1 SIG_SKIP_19
    s_cmp_lg_u32 s62, 0
    s_cbranch_scc1 TAG_DONE_20
    s_mov_b32 s63, 0
    v_mov_b32 v6, 0
TAG_LOOP_21:
    buffer_load_dword v7, v6, s[12:15], 0 offen sc1
    s_waitcnt vmcnt(0)
    v_readfirstlane_b32 s62, v7
    s_nop 3
    s_sub_i32 m0, s62, s41
    s_abs_i32 m0, m0
    s_cmp_lt_u32 m0, 20000
    s_cselect_b32 s62, s62, 0
    s_add_u32 s63, s63, 1
    s_cmp_lg_u32 s62, 0
    s_cbranch_scc1 TAG_DONE_20
    s_sleep 4
    s_cmp_lt_u32 s63, 40000
    s_cbranch_scc1 TAG_LOOP_21
TAG_DONE_20:
    v_mul_u32_u24 v6, 33792, v1
    v_mov_b32 v7, s62
    s_mov_b64 exec, 0xFF
    buffer_store_dword v7, v6, s[8:11], s30 offen sc1
    s_mov_b64 exec, -1
SIG_SKIP_19:
P1_NODEF:
    s_mov_b32 s49, 0
    v_mov_b32 v200, 0x7f000000
    v_mov_b32 v201, 0x7f000000
    v_mov_b32 v202, 0x7f000000
    v_mov_b32 v203, 0x7f000000
    v_mov_b32 v204, 0x7f000000
    v_mov_b32 v205, 0x7f000000
    v_mov_b32 v206, 0x7f000000
    v_mov_b32 v207, 0x7f000000
P2:
    s_setprio 3
    s_and_b32 s30, s2, 7
    s_lshr_b32 s31, s2, 3
    s_lshr_b32 s17, s31, 3
    s_lshl_b32 s30, s30, 2
    s_add_u32 s17, s17, s30
    s_and_b32 s18, s31, 7
    s_lshr_b32 s24, s16, 2
    s_and_b32 s19, s16, 3
    s_mul_i32 s30, s17, 20
    s_lshr_b32 s54, s30, 7
    s_add_u32 s30, s30, 19
    s_lshr_b32 s55, s30, 7
    v_lshrrev_b32 v5, 5, v1
    v_mul_u32_u24 v5, 5, v5
    v_add_u32 v5, 5, v5
    v_and_b32 v6, 16, v1
    v_cmp_eq_u32 vcc, 0, v6
    v_mov_b32 v6, s54
    v_mov_b32 v7, s55
    v_cndmask_b32 v6, v7, v6, vcc
    v_add_u32 v5, v5, v6
    v_lshlrev_b32 v5, 4, v5
    v_and_b32 v6, 15, v1
    v_add_u32 v5, v5, v6
    v_lshlrev_b32 v5, 6, v5
    s_and_b32 s30, s2, 7
    s_mul_i32 s53, s30, 33792
    v_add_u32 v8, 131072, v5
    v_add_u32 v8, s53, v8
    v_and_b32 v5, 1, v1
    v_cmp_eq_u32 vcc, 0, v5
    v_mov_b32 v6, s54
    v_mov_b32 v7, s55
    v_cndmask_b32 v6, v7, v6, vcc
    v_lshlrev_b32 v6, 4, v6
    v_bfe_u32 v7, v1, 1, 1
    s_lshl_b32 s30, s18, 1
    v_add3_u32 v6, v6, v7, s30
    v_lshlrev_b32 v6, 6, v6
    v_add_u32 v9, 131072, v6
    v_add_u32 v6, s30, v5
    v_lshlrev_b32 v6, 6, v6
    v_add_u32 v6, 146432, v6
    v_cmp_le_u32 vcc, 4, v1
    s_nop 1
    v_cndmask_b32 v9, v9, v6, vcc
    v_add_u32 v9, s53, v9
    v_lshlrev_b32 v2, 4, v1
    v_and_b32 v5, 31, v1
    v_lshrrev_b32 v6, 5, v1
    s_and_b32 s29, s17, 1
    s_lshl_b32 s30, s29, 3
    s_add_u32 s30, s30, 1024
    v_and_b32 v7, 15, v5
    v_lshlrev_b32 v7, 4, v7
    v_add_u32 v7, s30, v7
    v_lshrrev_b32 v10, 4, v5
    v_mul_u32_u24 v3, 163840, v10
    v_add_u32 v3, v3, v7
    v_mul_u32_u24 v208, 81920, v10
    v_add_u32 v208, v208, v7
    s_mul_i32 s50, s29, 163840
    s_mul_i32 s51, s29, 81920
    v_mul_u32_u24 v4, 320, v6
    v_lshlrev_b32 v7, 4, v5
    v_add3_u32 v4, v4, v7, 0
    v_add_u32 v4, 1280, v4
    s_lshl_b32 s27, s17, 6
    s_lshl_b32 s26, s18, 2
    s_lshl_b32 s30, s24, 5
    s_add_u32 s26, s26, s30
    s_add_u32 s28, s27, s26
    s_mul_i32 s28, s28, 1280
    s_add_u32 s28, s28, 3932160
    s_mul_i32 s25, s19, 40960
    s_add_u32 s25, s25, s50
    s_and_b32 s30, s17, 30
    s_mul_i32 s30, s30, 163840
    s_add_u32 s30, s30, 11796480
    s_add_u32 s4, s42, s30
    s_addc_u32 s5, s43, 0
    s_mov_b32 s6, 327680
    s_mov_b32 s7, 0x20000
    v_cmp_eq_u32 vcc, 20, v5
    v_mov_b32 v7, 0x3f803f80
    v_mov_b32 v10, 0
    v_cndmask_b32 v7, v10, v7, vcc
    v_mov_b32 v140, v7
    v_mov_b32 v141, v7
    v_mov_b32 v142, v7
    v_mov_b32 v143, v7
    v_mov_b32 v144, v7
    v_mov_b32 v145, v7
    v_mov_b32 v146, v7
    v_mov_b32 v147, v7
    v_mov_b32 v148, v7
    v_mov_b32 v149, v7
    v_mov_b32 v150, v7
    v_mov_b32 v151, v7
    v_mov_b32 v152, v7
    v_mov_b32 v153, v7
    v_mov_b32 v154, v7
    v_mov_b32 v155, v7
    v_mov_b32 v156, v7
    v_mov_b32 v157, v7
    v_mov_b32 v158, v7
    v_mov_b32 v159, v7
    v_mov_b32 v160, v7
    v_mov_b32 v161, v7
    v_mov_b32 v162, v7
    v_mov_b32 v163, v7
    v_mov_b32 v164, v7
    v_mov_b32 v165, v7
    v_mov_b32 v166, v7
    v_mov_b32 v167, v7
    v_mov_b32 v120, 0
    v_mov_b32 v121, 0
    v_mov_b32 v122, 0
    v_mov_b32 v123, 0
    v_mov_b32 v124, 0
    v_mov_b32 v125, 0
    v_mov_b32 v126, 0
    v_mov_b32 v127, 0
    v_mov_b32 v136, 0x3f803f80
    v_mov_b32 v137, 0x3F80
    v_mov_b32 v138, 0x3f803f80
    v_mov_b32 v139, 0x3F80
    s_cmp_lg_u32 s16, 0
    s_cbranch_scc1 P2_OUT_24
    s_cmp_lg_u32 s62, 0
    s_cbranch_scc1 TAG_DONE_25
    s_mov_b32 s63, 0
    v_mov_b32 v6, 0
TAG_LOOP_26:
    buffer_load_dword v7, v6, s[12:15], 0 offen sc1
    s_waitcnt vmcnt(0)
    v_readfirstlane_b32 s62, v7
    s_nop 3
    s_sub_i32 m0, s62, s41
    s_abs_i32 m0, m0
    s_cmp_lt_u32 m0, 20000
    s_cselect_b32 s62, s62, 0
    s_add_u32 s63, s63, 1
    s_cmp_lg_u32 s62, 0
    s_cbranch_scc1 TAG_DONE_25
    s_sleep 4
    s_cmp_lt_u32 s63, 40000
    s_cbranch_scc1 TAG_LOOP_26
TAG_DONE_25:
    s_mov_b32 s63, 0
P2_POLL_22:
    buffer_load_dword v10, v8, s[8:11], 0 offen sc1
    buffer_load_dword v11, v9, s[8:11], 0 offen sc1
    s_waitcnt vmcnt(0)
    v_cmp_ne_u32 vcc, s62, v10
    v_cmp_ne_u32 s[30:31], s62, v11
    s_add_u32 s63, s63, 1
    s_nop 0
    s_or_b64 vcc, vcc, s[30:31]
    s_cbranch_vccz P2_GO_23
    s_sleep 6
    s_cmp_lt_u32 s63, 40000
    s_cbranch_scc1 P2_POLL_22
P2_GO_23:
P2_OUT_24:
    s_barrier
    s_cmp_lg_u32 s62, 0
    s_cbranch_scc1 TAG_DONE_27
    s_mov_b32 s63, 0
    v_mov_b32 v6, 0
TAG_LOOP_28:
    buffer_load_dword v7, v6, s[12:15], 0 offen sc1
    s_waitcnt vmcnt(0)
    v_readfirstlane_b32 s62, v7
    s_nop 3
    s_sub_i32 m0, s62, s41
    s_abs_i32 m0, m0
    s_cmp_lt_u32 m0, 20000
    s_cselect_b32 s62, s62, 0
    s_add_u32 s63, s63, 1
    s_cmp_lg_u32 s62, 0
    s_cbranch_scc1 TAG_DONE_27
    s_sleep 4
    s_cmp_lt_u32 s63, 40000
    s_cbranch_scc1 TAG_LOOP_28
TAG_DONE_27:
    buffer_load_dwordx4 v[128:131], v2, s[4:7], s25 offen offset:0 sc1
    s_sub_u32 s52, s25, s50
    s_mov_b64 exec, s[22:23]
    buffer_load_dwordx2 v[136:137], v3, s[4:7], s52 offen offset:0 sc1
    s_mov_b64 exec, -1
    buffer_load_dwordx4 v[104:107], v2, s[8:11], s28 offen offset:0 sc1
    buffer_load_dwordx4 v[108:111], v2, s[8:11], s28 offen offset:1280 sc1
    buffer_load_dwordx4 v[112:115], v2, s[8:11], s28 offen offset:2560 sc1
    buffer_load_dwordx4 v[116:119], v2, s[8:11], s28 offen offset:3840 sc1
    s_mov_b64 exec, s[22:23]
    s_sub_u32 s29, s28, s51
    s_add_u32 s30, s29, 2560
    buffer_load_dwordx2 v[120:121], v208, s[8:11], s29 offen offset:0 sc1
    buffer_load_dwordx2 v[122:123], v208, s[8:11], s29 offen offset:1280 sc1
    buffer_load_dwordx2 v[124:125], v208, s[8:11], s30 offen offset:0 sc1
    buffer_load_dwordx2 v[126:127], v208, s[8:11], s30 offen offset:1280 sc1
    s_mov_b64 exec, -1
    s_mov_b64 exec, s[20:21]
    buffer_load_dwordx4 v[140:143], v4, s[4:7], s25 offen offset:0 sc1
    buffer_load_dwordx4 v[144:147], v4, s[4:7], s25 offen offset:640 sc1
    s_mov_b64 exec, -1
    buffer_load_dwordx4 v[132:135], v2, s[4:7], s25 offen offset:2560 sc1
    s_sub_u32 s52, s25, s50
    s_mov_b64 exec, s[22:23]
    buffer_load_dwordx2 v[138:139], v3, s[4:7], s52 offen offset:2560 sc1
    s_mov_b64 exec, -1
    s_waitcnt vmcnt(4)
    v_mfma_f32_32x32x16_bf16 v[40:55], v[128:131], v[104:107], 0
    v_mfma_f32_32x32x8_bf16 v[40:55], v[136:137], v[120:121], v[40:55]
    v_mfma_f32_32x32x16_bf16 v[56:71], v[128:131], v[108:111], 0
    v_mfma_f32_32x32x8_bf16 v[56:71], v[136:137], v[122:123], v[56:71]
    v_mfma_f32_32x32x16_bf16 v[72:87], v[128:131], v[112:115], 0
    v_mfma_f32_32x32x8_bf16 v[72:87], v[136:137], v[124:125], v[72:87]
    v_mfma_f32_32x32x16_bf16 v[88:103], v[128:131], v[116:119], 0
    v_mfma_f32_32x32x8_bf16 v[88:103], v[136:137], v[126:127], v[88:103]
    s_nop 5
    v_max3_f32 v7, v40, v41, v42
    v_max3_f32 v7, v7, v43, v44
    v_max3_f32 v7, v7, v45, v46
    v_max3_f32 v7, v7, v47, v48
    v_max3_f32 v7, v7, v49, v50
    v_max3_f32 v7, v7, v51, v52
    v_max3_f32 v7, v7, v53, v54
    v_max_f32 v7, v7, v55
    v_mov_b32 v5, v7
    s_nop 1
    v_permlane32_swap_b32 v5, v7
    s_nop 1
    v_max_f32 v7, v5, v7
    v_sub_f32 v7, 0, v7
    v_cvt_pk_bf16_f32 v7, v7, 0
    s_mov_b64 exec, s[56:57]
    v_mov_b32 v120, v7
    s_mov_b64 exec, -1
    v_max3_f32 v7, v56, v57, v58
    v_max3_f32 v7, v7, v59, v60
    v_max3_f32 v7, v7, v61, v62
    v_max3_f32 v7, v7, v63, v64
    v_max3_f32 v7, v7, v65, v66
    v_max3_f32 v7, v7, v67, v68
    v_max3_f32 v7, v7, v69, v70
    v_max_f32 v7, v7, v71
    v_mov_b32 v5, v7
    s_nop 1
    v_permlane32_swap_b32 v5, v7
    s_nop 1
    v_max_f32 v7, v5, v7
    v_sub_f32 v7, 0, v7
    v_cvt_pk_bf16_f32 v7, v7, 0
    s_mov_b64 exec, s[56:57]
    v_mov_b32 v122, v7
    s_mov_b64 exec, -1
    v_max3_f32 v7, v72, v73, v74
    v_max3_f32 v7, v7, v75, v76
    v_max3_f32 v7, v7, v77, v78
    v_max3_f32 v7, v7, v79, v80
    v_max3_f32 v7, v7, v81, v82
    v_max3_f32 v7, v7, v83, v84
    v_max3_f32 v7, v7, v85, v86
    v_max_f32 v7, v7, v87
    v_mov_b32 v5, v7
    s_nop 1
    v_permlane32_swap_b32 v5, v7
    s_nop 1
    v_max_f32 v7, v5, v7
    v_sub_f32 v7, 0, v7
    v_cvt_pk_bf16_f32 v7, v7, 0
    s_mov_b64 exec, s[56:57]
    v_mov_b32 v124, v7
    s_mov_b64 exec, -1
    s_nop 1
    v_max3_f32 v7, v88, v89, v90
    v_max3_f32 v7, v7, v91, v92
    v_max3_f32 v7, v7, v93, v94
    v_max3_f32 v7, v7, v95, v96
    v_max3_f32 v7, v7, v97, v98
    v_max3_f32 v7, v7, v99, v100
    v_max3_f32 v7, v7, v101, v102
    v_max_f32 v7, v7, v103
    v_mov_b32 v5, v7
    s_nop 1
    v_permlane32_swap_b32 v5, v7
    s_nop 1
    v_max_f32 v7, v5, v7
    v_sub_f32 v7, 0, v7
    v_cvt_pk_bf16_f32 v7, v7, 0
    s_mov_b64 exec, s[56:57]
    v_mov_b32 v126, v7
    s_mov_b64 exec, -1
    s_nop 0
    v_mfma_f32_32x32x16_bf16 v[8:23], v[128:131], v[104:107], 0
    v_mfma_f32_32x32x8_bf16 v[8:23], v[136:137], v[120:121], v[8:23]
    buffer_store_dwordx4 v[168:171], v200, s[8:11], 0 offen sc1
    buffer_store_dwordx4 v[172:175], v201, s[8:11], 0 offen sc1
    buffer_store_dwordx4 v[176:179], v202, s[8:11], 0 offen sc1
    buffer_store_dwordx4 v[180:183], v203, s[8:11], 0 offen sc1
    buffer_store_dwordx4 v[184:187], v204, s[8:11], 0 offen sc1
    buffer_store_dwordx4 v[188:191], v205, s[8:11], 0 offen sc1
    buffer_store_dwordx4 v[192:195], v206, s[8:11], 0 offen sc1
    buffer_store_dwordx4 v[196:199], v207, s[8:11], 0 offen sc1
    v_mov_b32 v40, 0
    v_mov_b32 v41, 0
    v_mov_b32 v42, 0
    v_mov_b32 v43, 0
    v_mov_b32 v44, 0
    v_mov_b32 v45, 0
    v_mov_b32 v46, 0
    v_mov_b32 v47, 0
    v_mov_b32 v48, 0
    v_mov_b32 v49, 0
    v_mov_b32 v50, 0
    v_mov_b32 v51, 0
    v_mov_b32 v52, 0
    v_mov_b32 v53, 0
    v_mov_b32 v54, 0
    v_mov_b32 v55, 0
    v_mov_b32 v56, 0
    v_mov_b32 v57, 0
    v_mov_b32 v58, 0
    v_mov_b32 v59, 0
    v_mov_b32 v60, 0
    v_mov_b32 v61, 0
    v_mov_b32 v62, 0
    v_mov_b32 v63, 0
    v_mov_b32 v64, 0
    v_mov_b32 v65, 0
    v_mov_b32 v66, 0
    v_mov_b32 v67, 0
    v_mov_b32 v68, 0
    v_mov_b32 v69, 0
    v_mov_b32 v70, 0
    v_mov_b32 v71, 0
    v_mov_b32 v72, 0
    v_mov_b32 v73, 0
    v_mov_b32 v74, 0
    v_mov_b32 v75, 0
    v_mov_b32 v76, 0
    v_mov_b32 v77, 0
    v_mov_b32 v78, 0
    v_mov_b32 v79, 0
    v_mov_b32 v80, 0
    v_mov_b32 v81, 0
    v_mov_b32 v82, 0
    v_mov_b32 v83, 0
    v_mov_b32 v84, 0
    v_mov_b32 v85, 0
    v_mov_b32 v86, 0
    v_mov_b32 v87, 0
    v_mov_b32 v88, 0
    v_mov_b32 v89, 0
    v_mov_b32 v90, 0
    v_mov_b32 v91, 0
    v_mov_b32 v92, 0
    v_mov_b32 v93, 0
    v_mov_b32 v94, 0
    v_mov_b32 v95, 0
    v_mov_b32 v96, 0
    v_mov_b32 v97, 0
    v_mov_b32 v98, 0
    v_mov_b32 v99, 0
    v_mov_b32 v100, 0
    v_mov_b32 v101, 0
    v_mov_b32 v102, 0
    v_mov_b32 v103, 0
    v_mov_b32 v32, 0
    v_mov_b32 v33, 0
    v_mov_b32 v34, 0
    v_mov_b32 v35, 0
    s_mov_b32 s40, 0
    s_setprio 1
.p2align 2
    v_exp_f32 v8, v8
    v_exp_f32 v9, v9
    v_mfma_f32_32x32x16_bf16 v[88:103], v[152:155], v[32:35], v[88:103]
    v_exp_f32 v10, v10
    s_add_u32 s53, s25, 2560
    s_mov_b64 exec, s[20:21]
    buffer_load_dwordx4 v[148:151], v4, s[4:7], s53 offen offset:0 sc1
    buffer_load_dwordx4 v[152:155], v4, s[4:7], s53 offen offset:640 sc1
    s_mov_b64 exec, -1
    v_exp_f32 v11, v11
    v_cvt_pk_bf16_f32 v8, v8, v9
    v_cvt_pk_bf16_f32 v9, v10, v11
    v_exp_f32 v12, v12
    v_exp_f32 v13, v13
    v_mfma_f32_32x32x16_bf16 v[24:39], v[128:131], v[108:111], 0
    v_exp_f32 v14, v14
    v_exp_f32 v15, v15
    v_cvt_pk_bf16_f32 v10, v12, v13
    v_cvt_pk_bf16_f32 v11, v14, v15
    v_exp_f32 v16, v16
    v_mfma_f32_32x32x8_bf16 v[24:39], v[136:137], v[122:123], v[24:39]
    v_exp_f32 v17, v17
    v_exp_f32 v18, v18
    v_exp_f32 v19, v19
    v_cvt_pk_bf16_f32 v16, v16, v17
    v_cvt_pk_bf16_f32 v17, v18, v19
    v_exp_f32 v20, v20
    s_waitcnt vmcnt(12)
    v_exp_f32 v21, v21
    v_mfma_f32_32x32x16_bf16 v[40:55], v[140:143], v[8:11], v[40:55]
    v_exp_f32 v22, v22
    v_exp_f32 v23, v23
    v_cvt_pk_bf16_f32 v18, v20, v21
    v_cvt_pk_bf16_f32 v19, v22, v23
    v_exp_f32 v24, v24
    v_exp_f32 v25, v25
    v_mfma_f32_32x32x16_bf16 v[40:55], v[144:147], v[16:19], v[40:55]
    v_exp_f32 v26, v26
    v_exp_f32 v27, v27
    v_cvt_pk_bf16_f32 v24, v24, v25
    v_cvt_pk_bf16_f32 v25, v26, v27
    v_exp_f32 v28, v28
    v_exp_f32 v29, v29
    v_mfma_f32_32x32x16_bf16 v[8:23], v[128:131], v[112:115], 0
    v_exp_f32 v30, v30
    v_exp_f32 v31, v31
    v_cvt_pk_bf16_f32 v26, v28, v29
    v_cvt_pk_bf16_f32 v27, v30, v31
    v_exp_f32 v32, v32
    v_mfma_f32_32x32x8_bf16 v[8:23], v[136:137], v[124:125], v[8:23]
    v_exp_f32 v33, v33
    v_exp_f32 v34, v34
    v_exp_f32 v35, v35
    v_cvt_pk_bf16_f32 v32, v32, v33
    v_cvt_pk_bf16_f32 v33, v34, v35
    v_exp_f32 v36, v36
    v_exp_f32 v37, v37
    v_mfma_f32_32x32x16_bf16 v[56:71], v[140:143], v[24:27], v[56:71]
    v_exp_f32 v38, v38
    v_exp_f32 v39, v39
    v_cvt_pk_bf16_f32 v34, v36, v37
    v_cvt_pk_bf16_f32 v35, v38, v39
    v_exp_f32 v8, v8
    v_exp_f32 v9, v9
    v_mfma_f32_32x32x16_bf16 v[56:71], v[144:147], v[32:35], v[56:71]
    v_exp_f32 v10, v10
    v_exp_f32 v11, v11
    v_cvt_pk_bf16_f32 v8, v8, v9
    v_cvt_pk_bf16_f32 v9, v10, v11
    v_exp_f32 v12, v12
    v_exp_f32 v13, v13
    v_mfma_f32_32x32x16_bf16 v[24:39], v[128:131], v[116:119], 0
    v_exp_f32 v14, v14
    v_exp_f32 v15, v15
    v_cvt_pk_bf16_f32 v10, v12, v13
    v_cvt_pk_bf16_f32 v11, v14, v15
    v_exp_f32 v16, v16
    v_mfma_f32_32x32x8_bf16 v[24:39], v[136:137], v[126:127], v[24:39]
    v_exp_f32 v17, v17
    v_exp_f32 v18, v18
    v_exp_f32 v19, v19
    v_cvt_pk_bf16_f32 v16, v16, v17
    v_cvt_pk_bf16_f32 v17, v18, v19
    v_exp_f32 v20, v20
    v_exp_f32 v21, v21
    v_mfma_f32_32x32x16_bf16 v[72:87], v[140:143], v[8:11], v[72:87]
    v_exp_f32 v22, v22
    v_exp_f32 v23, v23
    v_cvt_pk_bf16_f32 v18, v20, v21
    v_cvt_pk_bf16_f32 v19, v22, v23
    v_exp_f32 v24, v24
    v_exp_f32 v25, v25
    v_mfma_f32_32x32x16_bf16 v[72:87], v[144:147], v[16:19], v[72:87]
    v_exp_f32 v26, v26
    s_add_u32 s53, s25, 5120
    buffer_load_dwordx4 v[128:131], v2, s[4:7], s53 offen offset:0 sc1
    s_sub_u32 s52, s53, s50
    s_mov_b64 exec, s[22:23]
    buffer_load_dwordx2 v[136:137], v3, s[4:7], s52 offen offset:0 sc1
    s_mov_b64 exec, -1
    v_exp_f32 v27, v27
    v_cvt_pk_bf16_f32 v24, v24, v25
    v_cvt_pk_bf16_f32 v25, v26, v27
    v_exp_f32 v28, v28
    s_waitcnt vmcnt(12)
    v_exp_f32 v29, v29
    v_mfma_f32_32x32x16_bf16 v[8:23], v[132:135], v[104:107], 0
    v_exp_f32 v30, v30
    v_exp_f32 v31, v31
    v_cvt_pk_bf16_f32 v26, v28, v29
    v_cvt_pk_bf16_f32 v27, v30, v31
    v_exp_f32 v32, v32
    v_mfma_f32_32x32x8_bf16 v[8:23], v[138:139], v[120:121], v[8:23]
    v_exp_f32 v33, v33
    v_exp_f32 v34, v34
    v_exp_f32 v35, v35
    v_cvt_pk_bf16_f32 v32, v32, v33
    v_cvt_pk_bf16_f32 v33, v34, v35
    v_exp_f32 v36, v36
    v_exp_f32 v37, v37
    v_mfma_f32_32x32x16_bf16 v[88:103], v[140:143], v[24:27], v[88:103]
    v_exp_f32 v38, v38
    v_exp_f32 v39, v39
    v_cvt_pk_bf16_f32 v34, v36, v37
    v_cvt_pk_bf16_f32 v35, v38, v39
    v_exp_f32 v8, v8
    v_exp_f32 v9, v9
    v_mfma_f32_32x32x16_bf16 v[88:103], v[144:147], v[32:35], v[88:103]
    v_exp_f32 v10, v10
    s_add_u32 s53, s25, 5120
    s_mov_b64 exec, s[20:21]
    buffer_load_dwordx4 v[140:143], v4, s[4:7], s53 offen offset:0 sc1
    buffer_load_dwordx4 v[144:147], v4, s[4:7], s53 offen offset:640 sc1
    s_mov_b64 exec, -1
    v_exp_f32 v11, v11
    v_cvt_pk_bf16_f32 v8, v8, v9
    v_cvt_pk_bf16_f32 v9, v10, v11
    v_exp_f32 v12, v12
    v_exp_f32 v13, v13
    v_mfma_f32_32x32x16_bf16 v[24:39], v[132:135], v[108:111], 0
    v_exp_f32 v14, v14
    v_exp_f32 v15, v15
    v_cvt_pk_bf16_f32 v10, v12, v13
    v_cvt_pk_bf16_f32 v11, v14, v15
    v_exp_f32 v16, v16
    v_mfma_f32_32x32x8_bf16 v[24:39], v[138:139], v[122:123], v[24:39]
    v_exp_f32 v17, v17
    v_exp_f32 v18, v18
    v_exp_f32 v19, v19
    v_cvt_pk_bf16_f32 v16, v16, v17
    v_cvt_pk_bf16_f32 v17, v18, v19
    v_exp_f32 v20, v20
    s_waitcnt vmcnt(4)
    v_exp_f32 v21, v21
    v_mfma_f32_32x32x16_bf16 v[40:55], v[148:151], v[8:11], v[40:55]
    v_exp_f32 v22, v22
    v_exp_f32 v23, v23
    v_cvt_pk_bf16_f32 v18, v20, v21
    v_cvt_pk_bf16_f32 v19, v22, v23
    v_exp_f32 v24, v24
    v_exp_f32 v25, v25
    v_mfma_f32_32x32x16_bf16 v[40:55], v[152:155], v[16:19], v[40:55]
    v_exp_f32 v26, v26
    v_exp_f32 v27, v27
    v_cvt_pk_bf16_f32 v24, v24, v25
    v_cvt_pk_bf16_f32 v25, v26, v27
    v_exp_f32 v28, v28
    v_exp_f32 v29, v29
    v_mfma_f32_32x32x16_bf16 v[8:23], v[132:135], v[112:115], 0
    v_exp_f32 v30, v30
    v_exp_f32 v31, v31
    v_cvt_pk_bf16_f32 v26, v28, v29
    v_cvt_pk_bf16_f32 v27, v30, v31
    v_exp_f32 v32, v32
    v_mfma_f32_32x32x8_bf16 v[8:23], v[138:139], v[124:125], v[8:23]
    v_exp_f32 v33, v33
    v_exp_f32 v34, v34
    v_exp_f32 v35, v35
    v_cvt_pk_bf16_f32 v32, v32, v33
    v_cvt_pk_bf16_f32 v33, v34, v35
    v_exp_f32 v36, v36
    v_exp_f32 v37, v37
    v_mfma_f32_32x32x16_bf16 v[56:71], v[148:151], v[24:27], v[56:71]
    v_exp_f32 v38, v38
    v_exp_f32 v39, v39
    v_cvt_pk_bf16_f32 v34, v36, v37
    v_cvt_pk_bf16_f32 v35, v38, v39
    v_exp_f32 v8, v8
    v_exp_f32 v9, v9
    v_mfma_f32_32x32x16_bf16 v[56:71], v[152:155], v[32:35], v[56:71]
    v_exp_f32 v10, v10
    v_exp_f32 v11, v11
    v_cvt_pk_bf16_f32 v8, v8, v9
    v_cvt_pk_bf16_f32 v9, v10, v11
    v_exp_f32 v12, v12
    v_exp_f32 v13, v13
    v_mfma_f32_32x32x16_bf16 v[24:39], v[132:135], v[116:119], 0
    v_exp_f32 v14, v14
    v_exp_f32 v15, v15
    v_cvt_pk_bf16_f32 v10, v12, v13
    v_cvt_pk_bf16_f32 v11, v14, v15
    v_exp_f32 v16, v16
    v_mfma_f32_32x32x8_bf16 v[24:39], v[138:139], v[126:127], v[24:39]
    v_exp_f32 v17, v17
    v_exp_f32 v18, v18
    v_exp_f32 v19, v19
    v_cvt_pk_bf16_f32 v16, v16, v17
    v_cvt_pk_bf16_f32 v17, v18, v19
    v_exp_f32 v20, v20
    v_exp_f32 v21, v21
    v_mfma_f32_32x32x16_bf16 v[72:87], v[148:151], v[8:11], v[72:87]
    v_exp_f32 v22, v22
    v_exp_f32 v23, v23
    v_cvt_pk_bf16_f32 v18, v20, v21
    v_cvt_pk_bf16_f32 v19, v22, v23
    v_exp_f32 v24, v24
    v_exp_f32 v25, v25
    v_mfma_f32_32x32x16_bf16 v[72:87], v[152:155], v[16:19], v[72:87]
    v_exp_f32 v26, v26
    s_add_u32 s53, s25, 7680
    buffer_load_dwordx4 v[132:135], v2, s[4:7], s53 offen offset:0 sc1
    s_sub_u32 s52, s53, s50
    s_mov_b64 exec, s[22:23]
    buffer_load_dwordx2 v[138:139], v3, s[4:7], s52 offen offset:0 sc1
    s_mov_b64 exec, -1
    v_exp_f32 v27, v27
    v_cvt_pk_bf16_f32 v24, v24, v25
    v_cvt_pk_bf16_f32 v25, v26, v27
    v_exp_f32 v28, v28
    s_waitcnt vmcnt(4)
    v_exp_f32 v29, v29
    v_mfma_f32_32x32x16_bf16 v[8:23], v[128:131], v[104:107], 0
    v_exp_f32 v30, v30
    v_exp_f32 v31, v31
    v_cvt_pk_bf16_f32 v26, v28, v29
    v_cvt_pk_bf16_f32 v27, v30, v31
    v_exp_f32 v32, v32
    v_mfma_f32_32x32x8_bf16 v[8:23], v[136:137], v[120:121], v[8:23]
    v_exp_f32 v33, v33
    v_exp_f32 v34, v34
    v_exp_f32 v35, v35
    v_cvt_pk_bf16_f32 v32, v32, v33
    v_cvt_pk_bf16_f32 v33, v34, v35
    v_exp_f32 v36, v36
    v_exp_f32 v37, v37
    v_mfma_f32_32x32x16_bf16 v[88:103], v[148:151], v[24:27], v[88:103]
    v_exp_f32 v38, v38
    v_exp_f32 v39, v39
    v_cvt_pk_bf16_f32 v34, v36, v37
    v_cvt_pk_bf16_f32 v35, v38, v39
    s_add_u32 s25, s25, 5120
    s_mov_b32 s40, 1
.p2align 2
P2_LOOP:
    v_exp_f32 v8, v8
    v_exp_f32 v9, v9
    v_mfma_f32_32x32x16_bf16 v[88:103], v[152:155], v[32:35], v[88:103]
    v_exp_f32 v10, v10
    s_add_u32 s53, s25, 2560
    s_mov_b64 exec, s[20:21]
    buffer_load_dwordx4 v[148:151], v4, s[4:7], s53 offen offset:0 sc1
    buffer_load_dwordx4 v[152:155], v4, s[4:7], s53 offen offset:640 sc1
    s_mov_b64 exec, -1
    v_exp_f32 v11, v11
    v_cvt_pk_bf16_f32 v8, v8, v9
    v_cvt_pk_bf16_f32 v9, v10, v11
    v_exp_f32 v12, v12
    v_exp_f32 v13, v13
    v_mfma_f32_32x32x16_bf16 v[24:39], v[128:131], v[108:111], 0
    v_exp_f32 v14, v14
    v_exp_f32 v15, v15
    v_cvt_pk_bf16_f32 v10, v12, v13
    v_cvt_pk_bf16_f32 v11, v14, v15
    v_exp_f32 v16, v16
    v_mfma_f32_32x32x8_bf16 v[24:39], v[136:137], v[122:123], v[24:39]
    v_exp_f32 v17, v17
    v_exp_f32 v18, v18
    v_exp_f32 v19, v19
    v_cvt_pk_bf16_f32 v16, v16, v17
    v_cvt_pk_bf16_f32 v17, v18, v19
    v_exp_f32 v20, v20
    s_waitcnt vmcnt(4)
    v_exp_f32 v21, v21
    v_mfma_f32_32x32x16_bf16 v[40:55], v[140:143], v[8:11], v[40:55]
    v_exp_f32 v22, v22
    v_exp_f32 v23, v23
    v_cvt_pk_bf16_f32 v18, v20, v21
    v_cvt_pk_bf16_f32 v19, v22, v23
    v_exp_f32 v24, v24
    v_exp_f32 v25, v25
    v_mfma_f32_32x32x16_bf16 v[40:55], v[144:147], v[16:19], v[40:55]
    v_exp_f32 v26, v26
    v_exp_f32 v27, v27
    v_cvt_pk_bf16_f32 v24, v24, v25
    v_cvt_pk_bf16_f32 v25, v26, v27
    v_exp_f32 v28, v28
    v_exp_f32 v29, v29
    v_mfma_f32_32x32x16_bf16 v[8:23], v[128:131], v[112:115], 0
    v_exp_f32 v30, v30
    v_exp_f32 v31, v31
    v_cvt_pk_bf16_f32 v26, v28, v29
    v_cvt_pk_bf16_f32 v27, v30, v31
    v_exp_f32 v32, v32
    v_mfma_f32_32x32x8_bf16 v[8:23], v[136:137], v[124:125], v[8:23]
    v_exp_f32 v33, v33
    v_exp_f32 v34, v34
    v_exp_f32 v35, v35
    v_cvt_pk_bf16_f32 v32, v32, v33
    v_cvt_pk_bf16_f32 v33, v34, v35
    v_exp_f32 v36, v36
    v_exp_f32 v37, v37
    v_mfma_f32_32x32x16_bf16 v[56:71], v[140:143], v[24:27], v[56:71]
    v_exp_f32 v38, v38
    v_exp_f32 v39, v39
    v_cvt_pk_bf16_f32 v34, v36, v37
    v_cvt_pk_bf16_f32 v35, v38, v39
    v_exp_f32 v8, v8
    v_exp_f32 v9, v9
    v_mfma_f32_32x32x16_bf16 v[56:71], v[144:147], v[32:35], v[56:71]
    v_exp_f32 v10, v10
    v_exp_f32 v11, v11
    v_cvt_pk_bf16_f32 v8, v8, v9
    v_cvt_pk_bf16_f32 v9, v10, v11
    v_exp_f32 v12, v12
    v_exp_f32 v13, v13
    v_mfma_f32_32x32x16_bf16 v[24:39], v[128:131], v[116:119], 0
    v_exp_f32 v14, v14
    v_exp_f32 v15, v15
    v_cvt_pk_bf16_f32 v10, v12, v13
    v_cvt_pk_bf16_f32 v11, v14, v15
    v_exp_f32 v16, v16
    v_mfma_f32_32x32x8_bf16 v[24:39], v[136:137], v[126:127], v[24:39]
    v_exp_f32 v17, v17
    v_exp_f32 v18, v18
    v_exp_f32 v19, v19
    v_cvt_pk_bf16_f32 v16, v16, v17
    v_cvt_pk_bf16_f32 v17, v18, v19
    v_exp_f32 v20, v20
    v_exp_f32 v21, v21
    v_mfma_f32_32x32x16_bf16 v[72:87], v[140:143], v[8:11], v[72:87]
    v_exp_f32 v22, v22
    v_exp_f32 v23, v23
    v_cvt_pk_bf16_f32 v18, v20, v21
    v_cvt_pk_bf16_f32 v19, v22, v23
    v_exp_f32 v24, v24
    v_exp_f32 v25, v25
    v_mfma_f32_32x32x16_bf16 v[72:87], v[144:147], v[16:19], v[72:87]
    v_exp_f32 v26, v26
    s_add_u32 s53, s25, 5120
    buffer_load_dwordx4 v[128:131], v2, s[4:7], s53 offen offset:0 sc1
    s_sub_u32 s52, s53, s50
    s_mov_b64 exec, s[22:23]
    buffer_load_dwordx2 v[136:137], v3, s[4:7], s52 offen offset:0 sc1
    s_mov_b64 exec, -1
    v_exp_f32 v27, v27
    v_cvt_pk_bf16_f32 v24, v24, v25
    v_cvt_pk_bf16_f32 v25, v26, v27
    v_exp_f32 v28, v28
    s_waitcnt vmcnt(4)
    v_exp_f32 v29, v29
    v_mfma_f32_32x32x16_bf16 v[8:23], v[132:135], v[104:107], 0
    v_exp_f32 v30, v30
    v_exp_f32 v31, v31
    v_cvt_pk_bf16_f32 v26, v28, v29
    v_cvt_pk_bf16_f32 v27, v30, v31
    v_exp_f32 v32, v32
    v_mfma_f32_32x32x8_bf16 v[8:23], v[138:139], v[120:121], v[8:23]
    v_exp_f32 v33, v33
    v_exp_f32 v34, v34
    v_exp_f32 v35, v35
    v_cvt_pk_bf16_f32 v32, v32, v33
    v_cvt_pk_bf16_f32 v33, v34, v35
    v_exp_f32 v36, v36
    v_exp_f32 v37, v37
    v_mfma_f32_32x32x16_bf16 v[88:103], v[140:143], v[24:27], v[88:103]
    v_exp_f32 v38, v38
    v_exp_f32 v39, v39
    v_cvt_pk_bf16_f32 v34, v36, v37
    v_cvt_pk_bf16_f32 v35, v38, v39
    v_exp_f32 v8, v8
    v_exp_f32 v9, v9
    v_mfma_f32_32x32x16_bf16 v[88:103], v[144:147], v[32:35], v[88:103]
    v_exp_f32 v10, v10
    s_add_u32 s53, s25, 5120
    s_mov_b64 exec, s[20:21]
    buffer_load_dwordx4 v[140:143], v4, s[4:7], s53 offen offset:0 sc1
    buffer_load_dwordx4 v[144:147], v4, s[4:7], s53 offen offset:640 sc1
    s_mov_b64 exec, -1
    v_exp_f32 v11, v11
    v_cvt_pk_bf16_f32 v8, v8, v9
    v_cvt_pk_bf16_f32 v9, v10, v11
    v_exp_f32 v12, v12
    v_exp_f32 v13, v13
    v_mfma_f32_32x32x16_bf16 v[24:39], v[132:135], v[108:111], 0
    v_exp_f32 v14, v14
    v_exp_f32 v15, v15
    v_cvt_pk_bf16_f32 v10, v12, v13
    v_cvt_pk_bf16_f32 v11, v14, v15
    v_exp_f32 v16, v16
    v_mfma_f32_32x32x8_bf16 v[24:39], v[138:139], v[122:123], v[24:39]
    v_exp_f32 v17, v17
    v_exp_f32 v18, v18
    v_exp_f32 v19, v19
    v_cvt_pk_bf16_f32 v16, v16, v17
    v_cvt_pk_bf16_f32 v17, v18, v19
    v_exp_f32 v20, v20
    s_waitcnt vmcnt(4)
    v_exp_f32 v21, v21
    v_mfma_f32_32x32x16_bf16 v[40:55], v[148:151], v[8:11], v[40:55]
    v_exp_f32 v22, v22
    v_exp_f32 v23, v23
    v_cvt_pk_bf16_f32 v18, v20, v21
    v_cvt_pk_bf16_f32 v19, v22, v23
    v_exp_f32 v24, v24
    v_exp_f32 v25, v25
    v_mfma_f32_32x32x16_bf16 v[40:55], v[152:155], v[16:19], v[40:55]
    v_exp_f32 v26, v26
    v_exp_f32 v27, v27
    v_cvt_pk_bf16_f32 v24, v24, v25
    v_cvt_pk_bf16_f32 v25, v26, v27
    v_exp_f32 v28, v28
    v_exp_f32 v29, v29
    v_mfma_f32_32x32x16_bf16 v[8:23], v[132:135], v[112:115], 0
    v_exp_f32 v30, v30
    v_exp_f32 v31, v31
    v_cvt_pk_bf16_f32 v26, v28, v29
    v_cvt_pk_bf16_f32 v27, v30, v31
    v_exp_f32 v32, v32
    v_mfma_f32_32x32x8_bf16 v[8:23], v[138:139], v[124:125], v[8:23]
    v_exp_f32 v33, v33
    v_exp_f32 v34, v34
    v_exp_f32 v35, v35
    v_cvt_pk_bf16_f32 v32, v32, v33
    v_cvt_pk_bf16_f32 v33, v34, v35
    v_exp_f32 v36, v36
    v_exp_f32 v37, v37
    v_mfma_f32_32x32x16_bf16 v[56:71], v[148:151], v[24:27], v[56:71]
    v_exp_f32 v38, v38
    v_exp_f32 v39, v39
    v_cvt_pk_bf16_f32 v34, v36, v37
    v_cvt_pk_bf16_f32 v35, v38, v39
    v_exp_f32 v8, v8
    v_exp_f32 v9, v9
    v_mfma_f32_32x32x16_bf16 v[56:71], v[152:155], v[32:35], v[56:71]
    v_exp_f32 v10, v10
    v_exp_f32 v11, v11
    v_cvt_pk_bf16_f32 v8, v8, v9
    v_cvt_pk_bf16_f32 v9, v10, v11
    v_exp_f32 v12, v12
    v_exp_f32 v13, v13
    v_mfma_f32_32x32x16_bf16 v[24:39], v[132:135], v[116:119], 0
    v_exp_f32 v14, v14
    v_exp_f32 v15, v15
    v_cvt_pk_bf16_f32 v10, v12, v13
    v_cvt_pk_bf16_f32 v11, v14, v15
    v_exp_f32 v16, v16
    v_mfma_f32_32x32x8_bf16 v[24:39], v[138:139], v[126:127], v[24:39]
    v_exp_f32 v17, v17
    v_exp_f32 v18, v18
    v_exp_f32 v19, v19
    v_cvt_pk_bf16_f32 v16, v16, v17
    v_cvt_pk_bf16_f32 v17, v18, v19
    v_exp_f32 v20, v20
    v_exp_f32 v21, v21
    v_mfma_f32_32x32x16_bf16 v[72:87], v[148:151], v[8:11], v[72:87]
    v_exp_f32 v22, v22
    v_exp_f32 v23, v23
    v_cvt_pk_bf16_f32 v18, v20, v21
    v_cvt_pk_bf16_f32 v19, v22, v23
    v_exp_f32 v24, v24
    v_exp_f32 v25, v25
    v_mfma_f32_32x32x16_bf16 v[72:87], v[152:155], v[16:19], v[72:87]
    v_exp_f32 v26, v26
    s_add_u32 s53, s25, 7680
    buffer_load_dwordx4 v[132:135], v2, s[4:7], s53 offen offset:0 sc1
    s_sub_u32 s52, s53, s50
    s_mov_b64 exec, s[22:23]
    buffer_load_dwordx2 v[138:139], v3, s[4:7], s52 offen offset:0 sc1
    s_mov_b64 exec, -1
    v_exp_f32 v27, v27
    v_cvt_pk_bf16_f32 v24, v24, v25
    v_cvt_pk_bf16_f32 v25, v26, v27
    v_exp_f32 v28, v28
    s_waitcnt vmcnt(4)
    v_exp_f32 v29, v29
    v_mfma_f32_32x32x16_bf16 v[8:23], v[128:131], v[104:107], 0
    v_exp_f32 v30, v30
    v_exp_f32 v31, v31
    v_cvt_pk_bf16_f32 v26, v28, v29
    v_cvt_pk_bf16_f32 v27, v30, v31
    v_exp_f32 v32, v32
    v_mfma_f32_32x32x8_bf16 v[8:23], v[136:137], v[120:121], v[8:23]
    v_exp_f32 v33, v33
    v_exp_f32 v34, v34
    v_exp_f32 v35, v35
    v_cvt_pk_bf16_f32 v32, v32, v33
    v_cvt_pk_bf16_f32 v33, v34, v35
    v_exp_f32 v36, v36
    v_exp_f32 v37, v37
    v_mfma_f32_32x32x16_bf16 v[88:103], v[148:151], v[24:27], v[88:103]
    v_exp_f32 v38, v38
    v_exp_f32 v39, v39
    v_cvt_pk_bf16_f32 v34, v36, v37
    v_cvt_pk_bf16_f32 v35, v38, v39
    s_add_u32 s25, s25, 5120
    s_add_u32 s40, s40, 1
    s_cmp_lg_u32 s40, 3
    s_cbranch_scc1 P2_NOFL_29
    s_cmp_eq_u32 s49, 0
    s_cbranch_scc1 P2_NOFL_29
    s_waitcnt vmcnt(0)
    v_mov_b32 v6, 0
    v_mov_b32 v7, s62
    s_mov_b64 exec, 1
    buffer_store_dword v7, v6, s[8:11], s49 offen sc1
    s_mov_b64 exec, -1
P2_NOFL_29:
    s_cmp_lt_u32 s40, 7
    s_cbranch_scc1 P2_LOOP
    s_cmp_ge_u32 s16, 4
    s_cbranch_scc1 P2_PRIO_30
    s_setprio 0
P2_PRIO_30:
.p2align 2
    v_exp_f32 v8, v8
    v_exp_f32 v9, v9
    v_mfma_f32_32x32x16_bf16 v[88:103], v[152:155], v[32:35], v[88:103]
    v_exp_f32 v10, v10
    s_add_u32 s53, s25, 2560
    s_mov_b64 exec, s[20:21]
    buffer_load_dwordx4 v[148:151], v4, s[4:7], s53 offen offset:0 sc1
    buffer_load_dwordx4 v[152:155], v4, s[4:7], s53 offen offset:640 sc1
    s_mov_b64 exec, -1
    v_exp_f32 v11, v11
    v_cvt_pk_bf16_f32 v8, v8, v9
    v_cvt_pk_bf16_f32 v9, v10, v11
    v_exp_f32 v12, v12
    v_exp_f32 v13, v13
    v_mfma_f32_32x32x16_bf16 v[24:39], v[128:131], v[108:111], 0
    v_exp_f32 v14, v14
    v_exp_f32 v15, v15
    v_cvt_pk_bf16_f32 v10, v12, v13
    v_cvt_pk_bf16_f32 v11, v14, v15
    v_exp_f32 v16, v16
    v_mfma_f32_32x32x8_bf16 v[24:39], v[136:137], v[122:123], v[24:39]
    v_exp_f32 v17, v17
    v_exp_f32 v18, v18
    v_exp_f32 v19, v19
    v_cvt_pk_bf16_f32 v16, v16, v17
    v_cvt_pk_bf16_f32 v17, v18, v19
    v_exp_f32 v20, v20
    s_waitcnt vmcnt(4)
    v_exp_f32 v21, v21
    v_mfma_f32_32x32x16_bf16 v[40:55], v[140:143], v[8:11], v[40:55]
    v_exp_f32 v22, v22
    v_exp_f32 v23, v23
    v_cvt_pk_bf16_f32 v18, v20, v21
    v_cvt_pk_bf16_f32 v19, v22, v23
    v_exp_f32 v24, v24
    v_exp_f32 v25, v25
    v_mfma_f32_32x32x16_bf16 v[40:55], v[144:147], v[16:19], v[40:55]
    v_exp_f32 v26, v26
    v_exp_f32 v27, v27
    v_cvt_pk_bf16_f32 v24, v24, v25
    v_cvt_pk_bf16_f32 v25, v26, v27
    v_exp_f32 v28, v28
    v_exp_f32 v29, v29
    v_mfma_f32_32x32x16_bf16 v[8:23], v[128:131], v[112:115], 0
    v_exp_f32 v30, v30
    v_exp_f32 v31, v31
    v_cvt_pk_bf16_f32 v26, v28, v29
    v_cvt_pk_bf16_f32 v27, v30, v31
    v_exp_f32 v32, v32
    v_mfma_f32_32x32x8_bf16 v[8:23], v[136:137], v[124:125], v[8:23]
    v_exp_f32 v33, v33
    v_exp_f32 v34, v34
    v_exp_f32 v35, v35
    v_cvt_pk_bf16_f32 v32, v32, v33
    v_cvt_pk_bf16_f32 v33, v34, v35
    v_exp_f32 v36, v36
    v_exp_f32 v37, v37
    v_mfma_f32_32x32x16_bf16 v[56:71], v[140:143], v[24:27], v[56:71]
    v_exp_f32 v38, v38
    v_exp_f32 v39, v39
    v_cvt_pk_bf16_f32 v34, v36, v37
    v_cvt_pk_bf16_f32 v35, v38, v39
    v_exp_f32 v8, v8
    v_exp_f32 v9, v9
    v_mfma_f32_32x32x16_bf16 v[56:71], v[144:147], v[32:35], v[56:71]
    v_exp_f32 v10, v10
    v_exp_f32 v11, v11
    v_cvt_pk_bf16_f32 v8, v8, v9
    v_cvt_pk_bf16_f32 v9, v10, v11
    v_exp_f32 v12, v12
    v_exp_f32 v13, v13
    v_mfma_f32_32x32x16_bf16 v[24:39], v[128:131], v[116:119], 0
    v_exp_f32 v14, v14
    v_exp_f32 v15, v15
    v_cvt_pk_bf16_f32 v10, v12, v13
    v_cvt_pk_bf16_f32 v11, v14, v15
    v_exp_f32 v16, v16
    v_mfma_f32_32x32x8_bf16 v[24:39], v[136:137], v[126:127], v[24:39]
    v_exp_f32 v17, v17
    v_exp_f32 v18, v18
    v_exp_f32 v19, v19
    v_cvt_pk_bf16_f32 v16, v16, v17
    v_cvt_pk_bf16_f32 v17, v18, v19
    v_exp_f32 v20, v20
    v_exp_f32 v21, v21
    v_mfma_f32_32x32x16_bf16 v[72:87], v[140:143], v[8:11], v[72:87]
    v_exp_f32 v22, v22
    v_exp_f32 v23, v23
    v_cvt_pk_bf16_f32 v18, v20, v21
    v_cvt_pk_bf16_f32 v19, v22, v23
    v_exp_f32 v24, v24
    v_exp_f32 v25, v25
    v_mfma_f32_32x32x16_bf16 v[72:87], v[144:147], v[16:19], v[72:87]
    v_exp_f32 v26, v26
    v_exp_f32 v27, v27
    v_cvt_pk_bf16_f32 v24, v24, v25
    v_cvt_pk_bf16_f32 v25, v26, v27
    v_exp_f32 v28, v28
    s_waitcnt vmcnt(2)
    v_exp_f32 v29, v29
    v_mfma_f32_32x32x16_bf16 v[8:23], v[132:135], v[104:107], 0
    v_exp_f32 v30, v30
    v_exp_f32 v31, v31
    v_cvt_pk_bf16_f32 v26, v28, v29
    v_cvt_pk_bf16_f32 v27, v30, v31
    v_exp_f32 v32, v32
    v_mfma_f32_32x32x8_bf16 v[8:23], v[138:139], v[120:121], v[8:23]
    v_exp_f32 v33, v33
    v_exp_f32 v34, v34
    v_exp_f32 v35, v35
    v_cvt_pk_bf16_f32 v32, v32, v33
    v_cvt_pk_bf16_f32 v33, v34, v35
    v_exp_f32 v36, v36
    v_exp_f32 v37, v37
    v_mfma_f32_32x32x16_bf16 v[88:103], v[140:143], v[24:27], v[88:103]
    v_exp_f32 v38, v38
    v_exp_f32 v39, v39
    v_cvt_pk_bf16_f32 v34, v36, v37
    v_cvt_pk_bf16_f32 v35, v38, v39
    s_lshl_b32 s33, s18, 2
    s_add_u32 s33, s33, s19
    s_lshl_b32 s30, s33, 6
    s_add_u32 s30, s30, s24
    v_and_b32 v5, 31, v1
    v_lshlrev_b32 v5, 1, v5
    v_add_u32 v5, s30, v5
    v_lshlrev_b32 v5, 2, v5
    buffer_load_dword v129, v5, s[8:11], 0 offen sc1
    v_add_u32 v5, 8192, v5
    buffer_load_dword v128, v5, s[8:11], 0 offen sc1
    s_mul_i32 s30, s17, 20
    s_lshr_b32 s34, s30, 6
    s_add_u32 s30, s30, 19
    s_lshr_b32 s35, s30, 6
    v_add_u32 v5, 2, v1
    v_lshrrev_b32 v5, 2, v5
    v_mul_u32_u24 v5, 10, v5
    v_and_b32 v6, 1, v1
    v_cmp_eq_u32 vcc, 0, v6
    v_mov_b32 v6, s34
    v_mov_b32 v7, s35
    v_cndmask_b32 v6, v7, v6, vcc
    v_add_u32 v5, v5, v6
    v_lshlrev_b32 v5, 5, v5
    s_and_b32 s34, s33, 30
    s_add_u32 s34, s34, s24
    s_sub_u32 s39, s33, 1
    s_max_i32 s39, s39, 0
    s_and_b32 s36, s39, 30
    s_add_u32 s36, s36, s24
    v_and_b32 v6, 3, v1
    v_cmp_gt_u32 vcc, 2, v6
    v_cmp_le_u32 s[30:31], 4, v1
    v_mov_b32 v6, s34
    v_mov_b32 v7, s36
    s_and_b64 vcc, vcc, s[30:31]
    s_nop 1
    v_cndmask_b32 v6, v6, v7, vcc
    v_add_u32 v5, v5, v6
    v_lshlrev_b32 v5, 6, v5
    v_add_u32 v5, 401408, v5
    s_and_b32 s30, s2, 7
    s_mul_i32 s30, s30, 33792
    s_add_u32 s30, s30, 146816
    v_lshlrev_b32 v6, 6, v1
    v_add_u32 v6, s30, v6
    v_cmp_le_u32 vcc, 10, v1
    s_nop 1
    v_cndmask_b32 v5, v5, v6, vcc
    s_mov_b64 exec, 0x3FFFFFF
    buffer_load_dword v6, v5, s[8:11], 0 offen sc1
    s_mov_b64 exec, -1
    v_exp_f32 v8, v8
    v_exp_f32 v9, v9
    v_mfma_f32_32x32x16_bf16 v[88:103], v[144:147], v[32:35], v[88:103]
    v_exp_f32 v10, v10
    v_exp_f32 v11, v11
    v_cvt_pk_bf16_f32 v8, v8, v9
    v_cvt_pk_bf16_f32 v9, v10, v11
    v_exp_f32 v12, v12
    v_exp_f32 v13, v13
    v_mfma_f32_32x32x16_bf16 v[24:39], v[132:135], v[108:111], 0
    v_exp_f32 v14, v14
    v_exp_f32 v15, v15
    v_cvt_pk_bf16_f32 v10, v12, v13
    v_cvt_pk_bf16_f32 v11, v14, v15
    v_exp_f32 v16, v16
    v_mfma_f32_32x32x8_bf16 v[24:39], v[138:139], v[122:123], v[24:39]
    v_exp_f32 v17, v17
    v_exp_f32 v18, v18
    v_exp_f32 v19, v19
    v_cvt_pk_bf16_f32 v16, v16, v17
    v_cvt_pk_bf16_f32 v17, v18, v19
    v_exp_f32 v20, v20
    s_waitcnt vmcnt(3)
    v_exp_f32 v21, v21
    v_mfma_f32_32x32x16_bf16 v[40:55], v[148:151], v[8:11], v[40:55]
    v_exp_f32 v22, v22
    v_exp_f32 v23, v23
    v_cvt_pk_bf16_f32 v18, v20, v21
    v_cvt_pk_bf16_f32 v19, v22, v23
    v_exp_f32 v24, v24
    v_exp_f32 v25, v25
    v_mfma_f32_32x32x16_bf16 v[40:55], v[152:155], v[16:19], v[40:55]
    v_exp_f32 v26, v26
    v_exp_f32 v27, v27
    v_cvt_pk_bf16_f32 v24, v24, v25
    v_cvt_pk_bf16_f32 v25, v26, v27
    v_exp_f32 v28, v28
    v_exp_f32 v29, v29
    v_mfma_f32_32x32x16_bf16 v[8:23], v[132:135], v[112:115], 0
    v_exp_f32 v30, v30
    v_exp_f32 v31, v31
    v_cvt_pk_bf16_f32 v26, v28, v29
    v_cvt_pk_bf16_f32 v27, v30, v31
    v_exp_f32 v32, v32
    v_mfma_f32_32x32x8_bf16 v[8:23], v[138:139], v[124:125], v[8:23]
    v_exp_f32 v33, v33
    v_exp_f32 v34, v34
    v_exp_f32 v35, v35
    v_cvt_pk_bf16_f32 v32, v32, v33
    v_cvt_pk_bf16_f32 v33, v34, v35
    v_exp_f32 v36, v36
    v_exp_f32 v37, v37
    v_mfma_f32_32x32x16_bf16 v[56:71], v[148:151], v[24:27], v[56:71]
    v_exp_f32 v38, v38
    v_exp_f32 v39, v39
    v_cvt_pk_bf16_f32 v34, v36, v37
    v_cvt_pk_bf16_f32 v35, v38, v39
    v_exp_f32 v8, v8
    v_exp_f32 v9, v9
    v_mfma_f32_32x32x16_bf16 v[56:71], v[152:155], v[32:35], v[56:71]
    v_exp_f32 v10, v10
    v_exp_f32 v11, v11
    v_cvt_pk_bf16_f32 v8, v8, v9
    v_cvt_pk_bf16_f32 v9, v10, v11
    v_exp_f32 v12, v12
    v_exp_f32 v13, v13
    v_mfma_f32_32x32x16_bf16 v[24:39], v[132:135], v[116:119], 0
    v_exp_f32 v14, v14
    v_exp_f32 v15, v15
    v_cvt_pk_bf16_f32 v10, v12, v13
    v_cvt_pk_bf16_f32 v11, v14, v15
    v_exp_f32 v16, v16
    v_mfma_f32_32x32x8_bf16 v[24:39], v[138:139], v[126:127], v[24:39]
    v_exp_f32 v17, v17
    v_exp_f32 v18, v18
    v_exp_f32 v19, v19
    v_cvt_pk_bf16_f32 v16, v16, v17
    v_cvt_pk_bf16_f32 v17, v18, v19
    v_exp_f32 v20, v20
    v_exp_f32 v21, v21
    v_mfma_f32_32x32x16_bf16 v[72:87], v[148:151], v[8:11], v[72:87]
    v_exp_f32 v22, v22
    v_exp_f32 v23, v23
    v_cvt_pk_bf16_f32 v18, v20, v21
    v_cvt_pk_bf16_f32 v19, v22, v23
    v_exp_f32 v24, v24
    v_exp_f32 v25, v25
    v_mfma_f32_32x32x16_bf16 v[72:87], v[152:155], v[16:19], v[72:87]
    v_exp_f32 v26, v26
    v_exp_f32 v27, v27
    v_cvt_pk_bf16_f32 v24, v24, v25
    v_cvt_pk_bf16_f32 v25, v26, v27
    v_exp_f32 v28, v28
    v_exp_f32 v29, v29
    v_exp_f32 v30, v30
    v_exp_f32 v31, v31
    v_cvt_pk_bf16_f32 v26, v28, v29
    v_cvt_pk_bf16_f32 v27, v30, v31
    v_exp_f32 v32, v32
    v_exp_f32 v33, v33
    v_exp_f32 v34, v34
    v_exp_f32 v35, v35
    v_cvt_pk_bf16_f32 v32, v32, v33
    v_cvt_pk_bf16_f32 v33, v34, v35
    v_exp_f32 v36, v36
    v_exp_f32 v37, v37
    v_mfma_f32_32x32x16_bf16 v[88:103], v[148:151], v[24:27], v[88:103]
    v_exp_f32 v38, v38
    v_exp_f32 v39, v39
    v_cvt_pk_bf16_f32 v34, v36, v37
    v_cvt_pk_bf16_f32 v35, v38, v39
    s_nop 1
    v_mfma_f32_32x32x16_bf16 v[88:103], v[152:155], v[32:35], v[88:103]
    s_setprio 3
    s_waitcnt vmcnt(0)
    s_mov_b64 exec, 0x3FFFFFF
    v_cmp_ne_u32 vcc, s62, v6
    s_mov_b64 exec, -1
    s_cbranch_vccz P2_AOK_31
    s_cmp_lg_u32 s62, 0
    s_cbranch_scc1 TAG_DONE_35
    s_mov_b32 s63, 0
    v_mov_b32 v6, 0
TAG_LOOP_36:
    buffer_load_dword v7, v6, s[12:15], 0 offen sc1
    s_waitcnt vmcnt(0)
    v_readfirstlane_b32 s62, v7
    s_nop 3
    s_sub_i32 m0, s62, s41
    s_abs_i32 m0, m0
    s_cmp_lt_u32 m0, 20000
    s_cselect_b32 s62, s62, 0
    s_add_u32 s63, s63, 1
    s_cmp_lg_u32 s62, 0
    s_cbranch_scc1 TAG_DONE_35
    s_sleep 4
    s_cmp_lt_u32 s63, 40000
    s_cbranch_scc1 TAG_LOOP_36
TAG_DONE_35:
    s_mov_b32 s63, 0
    s_mov_b64 exec, 0x3FFFFFF
POLL_32:
    buffer_load_dword v6, v5, s[8:11], 0 offen sc1
    s_waitcnt vmcnt(0)
    v_cmp_ne_u32 vcc, s62, v6
    s_add_u32 s63, s63, 1
    s_nop 0
    s_cbranch_vccz POLL_DONE_33
    s_sleep 6
    s_cmp_lt_u32 s63, 40000
    s_cbranch_scc1 POLL_32
POLL_DONE_33:
    s_mov_b64 exec, -1
P2_AOK_31:
    s_mul_i32 s30, s19, 3328
    s_mul_i32 s31, s24, 53248
    s_add_u32 s30, s30, s31
    v_lshlrev_b32 v7, 2, v1
    v_add_u32 v7, s30, v7
    ds_write_b32 v7, v120 offset:3072
    ds_write_b32 v7, v122 offset:16384
    ds_write_b32 v7, v124 offset:29696
    ds_write_b32 v7, v126 offset:43008
    s_add_u32 s34, s26, s19
    s_add_u32 s35, s27, s34
    s_mul_i32 s36, s35, 1280
    s_add_u32 s36, s36, 1310720
    s_mul_i32 s37, s35, 2560
    s_add_u32 s37, s37, 6553600
    s_cmp_eq_u32 s33, 0
    s_cselect_b32 s38, 0, 2560
    s_sub_u32 s38, s37, s38
    v_mov_b32 v116, 0
    v_mov_b32 v117, 0
    v_mov_b32 v118, 0
    v_mov_b32 v119, 0
    v_mov_b32 v130, 0
    v_mov_b32 v131, 0
    buffer_load_dwordx4 v[104:107], v2, s[8:11], s36 offen sc1
    buffer_load_dwordx4 v[108:111], v2, s[8:11], s37 offen sc1
    buffer_load_dwordx4 v[112:115], v2, s[8:11], s38 offen sc1
    s_mov_b64 exec, s[22:23]
    s_sub_u32 s34, s36, s51
    s_sub_u32 s35, s37, s50
    s_sub_u32 s39, s38, s50
    buffer_load_dwordx2 v[116:117], v208, s[8:11], s34 offen sc1
    buffer_load_dwordx2 v[118:119], v3, s[8:11], s35 offen sc1
    buffer_load_dwordx2 v[130:131], v3, s[8:11], s39 offen sc1
    s_mov_b64 exec, s[20:21]
    buffer_load_dwordx4 v[156:159], v4, s[8:11], s37 offen sc1
    buffer_load_dwordx4 v[160:163], v4, s[8:11], s37 offen offset:640 sc1
    buffer_load_dwordx4 v[164:167], v4, s[8:11], s38 offen offset:640 sc1
    s_mov_b64 exec, -1
    v_add_u32 v5, s30, v2
    ds_write_b128 v5, v[40:43] offset:0
    ds_write_b128 v5, v[44:47] offset:1024
    ds_write_b128 v5, v[48:51] offset:2048
    ds_write_b128 v5, v[56:59] offset:13312
    ds_write_b128 v5, v[60:63] offset:14336
    ds_write_b128 v5, v[64:67] offset:15360
    ds_write_b128 v5, v[72:75] offset:26624
    ds_write_b128 v5, v[76:79] offset:27648
    ds_write_b128 v5, v[80:83] offset:28672
    ds_write_b128 v5, v[88:91] offset:39936
    ds_write_b128 v5, v[92:95] offset:40960
    ds_write_b128 v5, v[96:99] offset:41984
    s_waitcnt lgkmcnt(0)
    s_barrier
    s_mul_i32 s30, s19, 13312
    s_mul_i32 s31, s24, 53248
    s_add_u32 s30, s30, s31
    v_add_u32 v5, s30, v2
    v_and_b32 v7, 31, v1
    v_lshlrev_b32 v7, 2, v7
    v_add_u32 v7, s30, v7
    ds_read_b128 v[40:43], v5 offset:0
    ds_read_b128 v[44:47], v5 offset:1024
    ds_read_b128 v[48:51], v5 offset:2048
    ds_read_b32 v52, v7 offset:3200
    ds_read_b128 v[56:59], v5 offset:3328
    ds_read_b128 v[60:63], v5 offset:4352
    ds_read_b128 v[64:67], v5 offset:5376
    ds_read_b32 v68, v7 offset:6528
    ds_read_b128 v[72:75], v5 offset:6656
    ds_read_b128 v[76:79], v5 offset:7680
    ds_read_b128 v[80:83], v5 offset:8704
    ds_read_b32 v84, v7 offset:9856
    ds_read_b128 v[88:91], v5 offset:9984
    ds_read_b128 v[92:95], v5 offset:11008
    ds_read_b128 v[96:99], v5 offset:12032
    ds_read_b32 v100, v7 offset:13184
    s_add_u32 s30, s26, s19
    s_mul_i32 s30, s30, 81920
    s_add_u32 s30, s30, 17039360
    s_lshr_b32 s31, s17, 1
    s_mul_i32 s31, s31, 40
    s_and_b32 s39, s17, 1
    s_mul_i32 s29, s39, 24
    s_add_u32 s29, s29, s31
    s_lshl_b32 s29, s29, 5
    s_add_u32 s29, s29, s30
    s_add_u32 s31, s31, 16
    s_lshl_b32 s31, s31, 5
    s_lshl_b32 s39, s39, 3
    s_add_u32 s31, s31, s39
    s_add_u32 s31, s31, s30
    v_bfe_u32 v9, v1, 4, 1
    v_mul_u32_u24 v9, 40960, v9
    v_and_b32 v10, 15, v1
    v_lshlrev_b32 v10, 4, v10
    v_add_u32 v9, v9, v10
    v_add_u32 v133, s31, v9
    v_lshrrev_b32 v10, 5, v1
    v_lshlrev_b32 v10, 8, v10
    v_add3_u32 v132, v9, v10, s29
    s_waitcnt lgkmcnt(0)
    v_max3_f32 v11, |v48|, |v64|, |v80|
    v_max3_f32 v11, v11, |v96|, |v96|
    s_mov_b32 s30, 0x5d800000
    v_cmp_ngt_f32 s[34:35], s30, v11
    v_lshlrev_b32 v52, 16, v52
    v_lshlrev_b32 v68, 16, v68
    v_lshlrev_b32 v84, 16, v84
    v_lshlrev_b32 v100, 16, v100
    v_min_f32 v11, v52, v68
    v_min3_f32 v11, v11, v84, v100
    v_sub_f32 v52, v11, v52
    v_sub_f32 v68, v11, v68
    v_sub_f32 v84, v11, v84
    v_sub_f32 v100, v11, v100
    v_exp_f32 v52, v52
    v_exp_f32 v68, v68
    v_exp_f32 v84, v84
    v_exp_f32 v100, v100
    s_nop 0
    v_mul_f32 v40, v52, v40
    v_mul_f32 v41, v52, v41
    v_mul_f32 v42, v52, v42
    v_mul_f32 v43, v52, v43
    v_mul_f32 v44, v52, v44
    v_mul_f32 v45, v52, v45
    v_mul_f32 v46, v52, v46
    v_mul_f32 v47, v52, v47
    v_mul_f32 v48, v52, v48
    v_mul_f32 v49, v52, v49
    v_mul_f32 v50, v52, v50
    v_mul_f32 v51, v52, v51
    v_fmac_f32 v40, v68, v56
    v_fmac_f32 v41, v68, v57
    v_fmac_f32 v42, v68, v58
    v_fmac_f32 v43, v68, v59
    v_fmac_f32 v44, v68, v60
    v_fmac_f32 v45, v68, v61
    v_fmac_f32 v46, v68, v62
    v_fmac_f32 v47, v68, v63
    v_fmac_f32 v48, v68, v64
    v_fmac_f32 v49, v68, v65
    v_fmac_f32 v50, v68, v66
    v_fmac_f32 v51, v68, v67
    v_fmac_f32 v40, v84, v72
    v_fmac_f32 v41, v84, v73
    v_fmac_f32 v42, v84, v74
    v_fmac_f32 v43, v84, v75
    v_fmac_f32 v44, v84, v76
    v_fmac_f32 v45, v84, v77
    v_fmac_f32 v46, v84, v78
    v_fmac_f32 v47, v84, v79
    v_fmac_f32 v48, v84, v80
    v_fmac_f32 v49, v84, v81
    v_fmac_f32 v50, v84, v82
    v_fmac_f32 v51, v84, v83
    v_fmac_f32 v40, v100, v88
    v_fmac_f32 v41, v100, v89
    v_fmac_f32 v42, v100, v90
    v_fmac_f32 v43, v100, v91
    v_fmac_f32 v44, v100, v92
    v_fmac_f32 v45, v100, v93
    v_fmac_f32 v46, v100, v94
    v_fmac_f32 v47, v100, v95
    v_fmac_f32 v48, v100, v96
    v_fmac_f32 v49, v100, v97
    v_fmac_f32 v50, v100, v98
    v_fmac_f32 v51, v100, v99
    v_mov_b32 v11, 0
    v_fma_f32 v11, v40, 0, v11
    v_fma_f32 v11, v41, 0, v11
    v_fma_f32 v11, v42, 0, v11
    v_fma_f32 v11, v43, 0, v11
    v_fma_f32 v11, v44, 0, v11
    v_fma_f32 v11, v45, 0, v11
    v_fma_f32 v11, v46, 0, v11
    v_fma_f32 v11, v47, 0, v11
    v_fma_f32 v11, v48, 0, v11
    v_fma_f32 v11, v49, 0, v11
    v_fma_f32 v11, v50, 0, v11
    v_fma_f32 v11, v51, 0, v11
    v_cmp_u_f32 vcc, v11, v11
    s_or_b64 s[34:35], s[34:35], vcc
    v_mov_b32 v9, v48
    v_mov_b32 v10, v48
    s_nop 1
    v_permlane32_swap_b32 v9, v10
    s_mov_b32 s30, 0x30800000
    s_mov_b32 s31, 0x5f800000
    v_cmp_nle_f32 vcc, s30, v10
    s_or_b64 s[34:35], s[34:35], vcc
    v_cmp_nge_f32 vcc, s31, v10
    s_or_b64 s[34:35], s[34:35], vcc
    s_waitcnt vmcnt(0)
    s_cmp_lg_u64 s[34:35], 0
    s_cbranch_scc1 P2_SLOW
P2_SLOW_RET:
    v_mov_b32 v9, v48
    v_mov_b32 v10, v48
    s_nop 1
    v_permlane32_swap_b32 v9, v10
    s_nop 1
    v_rcp_f32 v9, v10
    s_nop 0
    v_mul_f32 v9, v9, v128
    v_mul_f32 v40, v9, v40
    v_mul_f32 v41, v9, v41
    v_mul_f32 v42, v9, v42
    v_mul_f32 v43, v9, v43
    v_mul_f32 v44, v9, v44
    v_mul_f32 v45, v9, v45
    v_mul_f32 v46, v9, v46
    v_mul_f32 v47, v9, v47
    v_mul_f32 v48, v9, v48
    v_mul_f32 v49, v9, v49
    v_mul_f32 v50, v9, v50
    v_mul_f32 v51, v9, v51
    v_cvt_pk_bf16_f32 v12, v40, v41
    v_cvt_pk_bf16_f32 v13, v42, v43
    v_cvt_pk_bf16_f32 v14, v44, v45
    v_cvt_pk_bf16_f32 v15, v46, v47
    v_cvt_pk_bf16_f32 v16, v48, v49
    v_cvt_pk_bf16_f32 v17, v50, v51
    s_mov_b32 s30, 20480
    s_nop 0
    v_permlane32_swap_b32 v12, v14
    v_permlane32_swap_b32 v13, v15
    buffer_store_dwordx4 v[12:15], v132, s[8:11], s30 offen sc1
    s_mov_b64 exec, s[22:23]
    buffer_store_dwordx2 v[16:17], v133, s[8:11], s30 offen sc1
    s_mov_b64 exec, -1
    v_mfma_f32_32x32x16_bf16 v[8:23], v[108:111], v[104:107], 0
    v_mfma_f32_32x32x8_bf16 v[8:23], v[118:119], v[116:117], v[8:23]
    v_mfma_f32_32x32x16_bf16 v[24:39], v[112:115], v[104:107], 0
    v_mfma_f32_32x32x8_bf16 v[24:39], v[130:131], v[116:117], v[24:39]
    v_mov_b32 v7, 0xff800000
    s_nop 11
    s_mov_b32 s44, 0xff
    s_mov_b32 s45, 0xff0
    v_cndmask_b32 v8, v7, v8, s[44:45]
    s_mov_b32 s46, 0x1fe
    s_mov_b32 s47, 0x1fe0
    v_cndmask_b32 v9, v7, v9, s[46:47]
    s_mov_b32 s48, 0x3fc
    s_mov_b32 s49, 0x3fc0
    v_cndmask_b32 v10, v7, v10, s[48:49]
    s_mov_b32 s50, 0x7f8
    s_mov_b32 s51, 0x7f80
    v_cndmask_b32 v11, v7, v11, s[50:51]
    s_mov_b32 s44, 0xff00
    s_mov_b32 s45, 0xff000
    v_cndmask_b32 v12, v7, v12, s[44:45]
    s_mov_b32 s46, 0x1fe00
    s_mov_b32 s47, 0x1fe000
    v_cndmask_b32 v13, v7, v13, s[46:47]
    s_mov_b32 s48, 0x3fc00
    s_mov_b32 s49, 0x3fc000
    v_cndmask_b32 v14, v7, v14, s[48:49]
    s_mov_b32 s50, 0x7f800
    s_mov_b32 s51, 0x7f8000
    v_cndmask_b32 v15, v7, v15, s[50:51]
    s_mov_b32 s44, 0xff0000
    s_mov_b32 s45, 0xff00000
    v_cndmask_b32 v16, v7, v16, s[44:45]
    s_mov_b32 s46, 0x1fe0000
    s_mov_b32 s47, 0x1fe00000
    v_cndmask_b32 v17, v7, v17, s[46:47]
    s_mov_b32 s48, 0x3fc0000
    s_mov_b32 s49, 0x3fc00000
    v_cndmask_b32 v18, v7, v18, s[48:49]
    s_mov_b32 s50, 0x7f80000
    s_mov_b32 s51, 0x7f800000
    v_cndmask_b32 v19, v7, v19, s[50:51]
    s_mov_b32 s44, 0xff000000
    s_mov_b32 s45, 0xf0000000
    v_cndmask_b32 v20, v7, v20, s[44:45]
    s_mov_b32 s46, 0xfe000000
    s_mov_b32 s47, 0xe0000000
    v_cndmask_b32 v21, v7, v21, s[46:47]
    s_mov_b32 s48, 0xfc000000
    s_mov_b32 s49, 0xc0000000
    v_cndmask_b32 v22, v7, v22, s[48:49]
    s_mov_b32 s50, 0xf8000000
    s_mov_b32 s51, 0x80000000
    v_cndmask_b32 v23, v7, v23, s[50:51]
    s_cmp_eq_u32 s33, 0
    s_cselect_b32 s52, 0, -1
    s_and_b32 s44, s52, 0x0
    s_and_b32 s45, s52, 0xf
    v_cndmask_b32 v36, v7, v36, s[44:45]
    s_and_b32 s46, s52, 0x1
    s_and_b32 s47, s52, 0x1f
    v_cndmask_b32 v37, v7, v37, s[46:47]
    s_and_b32 s48, s52, 0x3
    s_and_b32 s49, s52, 0x3f
    v_cndmask_b32 v38, v7, v38, s[48:49]
    s_and_b32 s50, s52, 0x7
    s_and_b32 s51, s52, 0x7f
    v_cndmask_b32 v39, v7, v39, s[50:51]
    v_max3_f32 v7, v8, v9, v10
    v_max3_f32 v7, v7, v11, v12
    v_max3_f32 v7, v7, v13, v14
    v_max3_f32 v7, v7, v15, v16
    v_max3_f32 v7, v7, v17, v18
    v_max3_f32 v7, v7, v19, v20
    v_max3_f32 v7, v7, v21, v22
    v_max3_f32 v7, v7, v23, v36
    v_max3_f32 v7, v7, v37, v38
    v_max_f32 v7, v7, v39
    v_mov_b32 v5, v7
    s_nop 1
    v_permlane32_swap_b32 v5, v7
    s_nop 1
    v_max_f32 v7, v5, v7
    v_sub_f32 v8, v8, v7
    v_sub_f32 v9, v9, v7
    v_sub_f32 v10, v10, v7
    v_sub_f32 v11, v11, v7
    v_sub_f32 v12, v12, v7
    v_sub_f32 v13, v13, v7
    v_sub_f32 v14, v14, v7
    v_sub_f32 v15, v15, v7
    v_sub_f32 v16, v16, v7
    v_sub_f32 v17, v17, v7
    v_sub_f32 v18, v18, v7
    v_sub_f32 v19, v19, v7
    v_sub_f32 v20, v20, v7
    v_sub_f32 v21, v21, v7
    v_sub_f32 v22, v22, v7
    v_sub_f32 v23, v23, v7
    v_sub_f32 v36, v36, v7
    v_sub_f32 v37, v37, v7
    v_sub_f32 v38, v38, v7
    v_sub_f32 v39, v39, v7
    v_exp_f32 v8, v8
    v_exp_f32 v9, v9
    v_exp_f32 v10, v10
    v_exp_f32 v11, v11
    v_exp_f32 v12, v12
    v_exp_f32 v13, v13
    v_exp_f32 v14, v14
    v_exp_f32 v15, v15
    v_exp_f32 v16, v16
    v_exp_f32 v17, v17
    v_exp_f32 v18, v18
    v_exp_f32 v19, v19
    v_exp_f32 v20, v20
    v_exp_f32 v21, v21
    v_exp_f32 v22, v22
    v_exp_f32 v23, v23
    v_exp_f32 v36, v36
    v_exp_f32 v37, v37
    v_exp_f32 v38, v38
    v_exp_f32 v39, v39
    s_nop 0
    v_cvt_pk_bf16_f32 v24, v8, v9
    v_cvt_pk_bf16_f32 v25, v10, v11
    v_cvt_pk_bf16_f32 v26, v12, v13
    v_cvt_pk_bf16_f32 v27, v14, v15
    v_cvt_pk_bf16_f32 v28, v16, v17
    v_cvt_pk_bf16_f32 v29, v18, v19
    v_cvt_pk_bf16_f32 v30, v20, v21
    v_cvt_pk_bf16_f32 v31, v22, v23
    v_mov_b32 v56, 0
    v_mov_b32 v57, 0
    v_cvt_pk_bf16_f32 v58, v36, v37
    v_cvt_pk_bf16_f32 v59, v38, v39
    s_nop 1
    v_mfma_f32_32x32x16_bf16 v[40:55], v[156:159], v[24:27], 0
    v_mfma_f32_32x32x16_bf16 v[40:55], v[160:163], v[28:31], v[40:55]
    v_mfma_f32_32x32x16_bf16 v[40:55], v[164:167], v[56:59], v[40:55]
    s_nop 11
    v_mov_b32 v5, v48
    v_mov_b32 v7, v48
    s_nop 1
    v_permlane32_swap_b32 v5, v7
    s_nop 1
    v_rcp_f32 v5, v7
    s_nop 0
    v_mul_f32 v5, v5, v129
    v_mul_f32 v40, v5, v40
    v_mul_f32 v41, v5, v41
    v_mul_f32 v42, v5, v42
    v_mul_f32 v43, v5, v43
    v_mul_f32 v44, v5, v44
    v_mul_f32 v45, v5, v45
    v_mul_f32 v46, v5, v46
    v_mul_f32 v47, v5, v47
    v_mul_f32 v48, v5, v48
    v_mul_f32 v49, v5, v49
    v_mul_f32 v50, v5, v50
    v_mul_f32 v51, v5, v51
    v_cvt_pk_bf16_f32 v8, v40, v41
    v_cvt_pk_bf16_f32 v9, v42, v43
    v_cvt_pk_bf16_f32 v10, v44, v45
    v_cvt_pk_bf16_f32 v11, v46, v47
    v_cvt_pk_bf16_f32 v12, v48, v49
    v_cvt_pk_bf16_f32 v13, v50, v51
    s_mov_b32 s30, 0
    s_nop 0
    v_permlane32_swap_b32 v8, v10
    v_permlane32_swap_b32 v9, v11
    buffer_store_dwordx4 v[8:11], v132, s[8:11], s30 offen sc1
    s_mov_b64 exec, s[22:23]
    buffer_store_dwordx2 v[12:13], v133, s[8:11], s30 offen sc1
    s_mov_b64 exec, -1
    s_lshl_b32 s30, s18, 5
    s_add_u32 s30, s30, s17
    s_lshl_b32 s30, s30, 6
    s_add_u32 s30, s30, 148480
    s_waitcnt vmcnt(0)
    s_barrier
    s_cmp_lg_u32 s16, 0
    s_cbranch_scc1 SIG_SKIP_37
    s_cmp_lg_u32 s62, 0
    s_cbranch_scc1 TAG_DONE_38
    s_mov_b32 s63, 0
    v_mov_b32 v6, 0
TAG_LOOP_39:
    buffer_load_dword v7, v6, s[12:15], 0 offen sc1
    s_waitcnt vmcnt(0)
    v_readfirstlane_b32 s62, v7
    s_nop 3
    s_sub_i32 m0, s62, s41
    s_abs_i32 m0, m0
    s_cmp_lt_u32 m0, 20000
    s_cselect_b32 s62, s62, 0
    s_add_u32 s63, s63, 1
    s_cmp_lg_u32 s62, 0
    s_cbranch_scc1 TAG_DONE_38
    s_sleep 4
    s_cmp_lt_u32 s63, 40000
    s_cbranch_scc1 TAG_LOOP_39
TAG_DONE_38:
    v_mul_u32_u24 v6, 33792, v1
    v_mov_b32 v7, s62
    s_mov_b64 exec, 0xFF
    buffer_store_dword v7, v6, s[8:11], s30 offen sc1
    s_mov_b64 exec, -1
SIG_SKIP_37:
    s_and_b32 s30, s2, 7
    s_lshr_b32 s31, s2, 3
    s_lshr_b32 s17, s31, 3
    s_lshl_b32 s30, s30, 2
    s_add_u32 s17, s17, s30
    s_and_b32 s18, s31, 7
    s_mul_i32 s19, s16, 5120
    v_lshlrev_b32 v2, 4, v1
    v_add_u32 v2, s19, v2
    v_add_u32 v3, 4096, v2
    s_mul_i32 s24, s17, 163840
    s_add_u32 s24, s24, 17039360
    s_add_u32 s25, s24, 40960
    s_add_u32 s26, s24, 81920
    s_add_u32 s27, s24, 122880
    s_mul_i32 s44, s18, 204800
    s_add_u32 s44, s44, 22282240
    s_add_u32 s45, s44, 40960
    s_add_u32 s46, s44, 81920
    s_add_u32 s47, s44, 122880
    s_add_u32 s48, s44, 163840
    s_mov_b32 s4, s58
    s_mov_b32 s5, s59
    s_mov_b32 s6, 2621440
    s_mov_b32 s7, 0x20000
    v_mov_b32 v176, 0
    v_mov_b32 v177, 0
    v_mov_b32 v178, 0
    v_mov_b32 v179, 0
    v_mov_b32 v180, 0
    v_mov_b32 v181, 0
    v_mov_b32 v182, 0
    v_mov_b32 v183, 0
    v_mov_b32 v184, 0
    v_mov_b32 v185, 0
    v_mov_b32 v186, 0
    v_mov_b32 v187, 0
    v_mov_b32 v188, 0
    v_mov_b32 v189, 0
    v_mov_b32 v190, 0
    v_mov_b32 v191, 0
    v_mov_b32 v192, 0
    v_mov_b32 v193, 0
    v_mov_b32 v194, 0
    v_mov_b32 v195, 0
    v_mov_b32 v196, 0
    v_mov_b32 v197, 0
    v_mov_b32 v198, 0
    v_mov_b32 v199, 0
    v_mov_b32 v200, 0
    v_mov_b32 v201, 0
    v_mov_b32 v202, 0
    v_mov_b32 v203, 0
    v_mov_b32 v204, 0
    v_mov_b32 v205, 0
    v_mov_b32 v206, 0
    v_mov_b32 v207, 0
    v_mov_b32 v208, 0
    v_mov_b32 v209, 0
    v_mov_b32 v210, 0
    v_mov_b32 v211, 0
    v_mov_b32 v212, 0
    v_mov_b32 v213, 0
    v_mov_b32 v214, 0
    v_mov_b32 v215, 0
    v_mov_b32 v216, 0
    v_mov_b32 v217, 0
    v_mov_b32 v218, 0
    v_mov_b32 v219, 0
    v_mov_b32 v220, 0
    v_mov_b32 v221, 0
    v_mov_b32 v222, 0
    v_mov_b32 v223, 0
    v_mov_b32 v224, 0
    v_mov_b32 v225, 0
    v_mov_b32 v226, 0
    v_mov_b32 v227, 0
    v_mov_b32 v228, 0
    v_mov_b32 v229, 0
    v_mov_b32 v230, 0
    v_mov_b32 v231, 0
    v_mov_b32 v232, 0
    v_mov_b32 v233, 0
    v_mov_b32 v234, 0
    v_mov_b32 v235, 0
    v_mov_b32 v236, 0
    v_mov_b32 v237, 0
    v_mov_b32 v238, 0
    v_mov_b32 v239, 0
    v_mov_b32 v240, 0
    v_mov_b32 v241, 0
    v_mov_b32 v242, 0
    v_mov_b32 v243, 0
    v_mov_b32 v244, 0
    v_mov_b32 v245, 0
    v_mov_b32 v246, 0
    v_mov_b32 v247, 0
    v_mov_b32 v248, 0
    v_mov_b32 v249, 0
    v_mov_b32 v250, 0
    v_mov_b32 v251, 0
    v_mov_b32 v252, 0
    v_mov_b32 v253, 0
    v_mov_b32 v254, 0
    v_mov_b32 v255, 0
    s_and_b32 s30, s2, 7
    s_mul_i32 s53, s30, 33792
    buffer_load_dwordx4 v[48:51], v2, s[8:11], s44 offen offset:0 sc1
    buffer_load_dwordx4 v[52:55], v2, s[8:11], s45 offen offset:0 sc1
    buffer_load_dwordx4 v[56:59], v2, s[8:11], s46 offen offset:0 sc1
    buffer_load_dwordx4 v[60:63], v2, s[8:11], s47 offen offset:0 sc1
    buffer_load_dwordx4 v[64:67], v2, s[8:11], s48 offen offset:0 sc1
    buffer_load_dwordx4 v[84:87], v2, s[8:11], s44 offen offset:1024 sc1
    buffer_load_dwordx4 v[88:91], v2, s[8:11], s45 offen offset:1024 sc1
    buffer_load_dwordx4 v[92:95], v2, s[8:11], s46 offen offset:1024 sc1
    buffer_load_dwordx4 v[96:99], v2, s[8:11], s47 offen offset:1024 sc1
    buffer_load_dwordx4 v[100:103], v2, s[8:11], s48 offen offset:1024 sc1
    buffer_load_dwordx4 v[120:123], v2, s[8:11], s44 offen offset:2048 sc1
    buffer_load_dwordx4 v[124:127], v2, s[8:11], s45 offen offset:2048 sc1
    buffer_load_dwordx4 v[128:131], v2, s[8:11], s46 offen offset:2048 sc1
    buffer_load_dwordx4 v[132:135], v2, s[8:11], s47 offen offset:2048 sc1
    buffer_load_dwordx4 v[136:139], v2, s[8:11], s48 offen offset:2048 sc1
    buffer_load_dwordx4 v[156:159], v2, s[8:11], s44 offen offset:3072 sc1
    buffer_load_dwordx4 v[160:163], v2, s[8:11], s45 offen offset:3072 sc1
    buffer_load_dwordx4 v[164:167], v2, s[8:11], s46 offen offset:3072 sc1
    buffer_load_dwordx4 v[168:171], v2, s[8:11], s47 offen offset:3072 sc1
    buffer_load_dwordx4 v[172:175], v2, s[8:11], s48 offen offset:3072 sc1
    buffer_load_dwordx4 v[12:15], v3, s[8:11], s44 offen offset:0 sc1
    buffer_load_dwordx4 v[16:19], v3, s[8:11], s45 offen offset:0 sc1
    buffer_load_dwordx4 v[20:23], v3, s[8:11], s46 offen offset:0 sc1
    buffer_load_dwordx4 v[24:27], v3, s[8:11], s47 offen offset:0 sc1
    buffer_load_dwordx4 v[28:31], v3, s[8:11], s48 offen offset:0 sc1
    s_and_b32 s30, s17, 15
    s_lshr_b32 s30, s30, 1
    s_lshl_b32 s30, s30, 11
    s_add_u32 s30, s30, 148480
    v_lshlrev_b32 v5, 6, v1
    v_add_u32 v5, s30, v5
    v_add_u32 v5, s53, v5
    s_cmp_lg_u32 s16, 0
    s_cbranch_scc1 POLL_OUT_42
    s_cmp_lg_u32 s62, 0
    s_cbranch_scc1 TAG_DONE_43
    s_mov_b32 s63, 0
    v_mov_b32 v6, 0
TAG_LOOP_44:
    buffer_load_dword v7, v6, s[12:15], 0 offen sc1
    s_waitcnt vmcnt(0)
    v_readfirstlane_b32 s62, v7
    s_nop 3
    s_sub_i32 m0, s62, s41
    s_abs_i32 m0, m0
    s_cmp_lt_u32 m0, 20000
    s_cselect_b32 s62, s62, 0
    s_add_u32 s63, s63, 1
    s_cmp_lg_u32 s62, 0
    s_cbranch_scc1 TAG_DONE_43
    s_sleep 4
    s_cmp_lt_u32 s63, 40000
    s_cbranch_scc1 TAG_LOOP_44
TAG_DONE_43:
    s_mov_b32 s63, 0
    s_mov_b64 exec, s[22:23]
POLL_40:
    buffer_load_dword v6, v5, s[8:11], 0 offen sc1
    s_waitcnt vmcnt(0)
    v_cmp_ne_u32 vcc, s62, v6
    s_add_u32 s63, s63, 1
    s_nop 0
    s_cbranch_vccz POLL_DONE_41
    s_sleep 6
    s_cmp_lt_u32 s63, 40000
    s_cbranch_scc1 POLL_40
POLL_DONE_41:
    s_mov_b64 exec, -1
POLL_OUT_42:
    s_barrier
    buffer_load_dwordx4 v[32:35], v2, s[8:11], s24 offen offset:0 sc1
    buffer_load_dwordx4 v[36:39], v2, s[8:11], s25 offen offset:0 sc1
    buffer_load_dwordx4 v[40:43], v2, s[8:11], s26 offen offset:0 sc1
    buffer_load_dwordx4 v[44:47], v2, s[8:11], s27 offen offset:0 sc1
    buffer_load_dwordx4 v[68:71], v2, s[8:11], s24 offen offset:1024 sc1
    buffer_load_dwordx4 v[72:75], v2, s[8:11], s25 offen offset:1024 sc1
    buffer_load_dwordx4 v[76:79], v2, s[8:11], s26 offen offset:1024 sc1
    buffer_load_dwordx4 v[80:83], v2, s[8:11], s27 offen offset:1024 sc1
    buffer_load_dwordx4 v[104:107], v2, s[8:11], s24 offen offset:2048 sc1
    buffer_load_dwordx4 v[108:111], v2, s[8:11], s25 offen offset:2048 sc1
    buffer_load_dwordx4 v[112:115], v2, s[8:11], s26 offen offset:2048 sc1
    buffer_load_dwordx4 v[116:119], v2, s[8:11], s27 offen offset:2048 sc1
    buffer_load_dwordx4 v[140:143], v2, s[8:11], s24 offen offset:3072 sc1
    buffer_load_dwordx4 v[144:147], v2, s[8:11], s25 offen offset:3072 sc1
    buffer_load_dwordx4 v[148:151], v2, s[8:11], s26 offen offset:3072 sc1
    buffer_load_dwordx4 v[152:155], v2, s[8:11], s27 offen offset:3072 sc1
    s_waitcnt vmcnt(12)
    v_mfma_f32_16x16x32_bf16 v[176:179], v[48:51], v[32:35], v[176:179]
    v_mfma_f32_16x16x32_bf16 v[180:183], v[52:55], v[32:35], v[180:183]
    v_mfma_f32_16x16x32_bf16 v[184:187], v[56:59], v[32:35], v[184:187]
    v_mfma_f32_16x16x32_bf16 v[188:191], v[60:63], v[32:35], v[188:191]
    v_mfma_f32_16x16x32_bf16 v[192:195], v[64:67], v[32:35], v[192:195]
    v_mfma_f32_16x16x32_bf16 v[196:199], v[48:51], v[36:39], v[196:199]
    v_mfma_f32_16x16x32_bf16 v[200:203], v[52:55], v[36:39], v[200:203]
    v_mfma_f32_16x16x32_bf16 v[204:207], v[56:59], v[36:39], v[204:207]
    v_mfma_f32_16x16x32_bf16 v[208:211], v[60:63], v[36:39], v[208:211]
    v_mfma_f32_16x16x32_bf16 v[212:215], v[64:67], v[36:39], v[212:215]
    v_mfma_f32_16x16x32_bf16 v[216:219], v[48:51], v[40:43], v[216:219]
    v_mfma_f32_16x16x32_bf16 v[220:223], v[52:55], v[40:43], v[220:223]
    v_mfma_f32_16x16x32_bf16 v[224:227], v[56:59], v[40:43], v[224:227]
    v_mfma_f32_16x16x32_bf16 v[228:231], v[60:63], v[40:43], v[228:231]
    v_mfma_f32_16x16x32_bf16 v[232:235], v[64:67], v[40:43], v[232:235]
    v_mfma_f32_16x16x32_bf16 v[236:239], v[48:51], v[44:47], v[236:239]
    v_mfma_f32_16x16x32_bf16 v[240:243], v[52:55], v[44:47], v[240:243]
    v_mfma_f32_16x16x32_bf16 v[244:247], v[56:59], v[44:47], v[244:247]
    v_mfma_f32_16x16x32_bf16 v[248:251], v[60:63], v[44:47], v[248:251]
    v_mfma_f32_16x16x32_bf16 v[252:255], v[64:67], v[44:47], v[252:255]
    buffer_load_dwordx4 v[32:35], v3, s[8:11], s24 offen offset:0 sc1
    buffer_load_dwordx4 v[36:39], v3, s[8:11], s25 offen offset:0 sc1
    buffer_load_dwordx4 v[40:43], v3, s[8:11], s26 offen offset:0 sc1
    buffer_load_dwordx4 v[44:47], v3, s[8:11], s27 offen offset:0 sc1
    s_waitcnt vmcnt(12)
    v_mfma_f32_16x16x32_bf16 v[176:179], v[84:87], v[68:71], v[176:179]
    v_mfma_f32_16x16x32_bf16 v[180:183], v[88:91], v[68:71], v[180:183]
    v_mfma_f32_16x16x32_bf16 v[184:187], v[92:95], v[68:71], v[184:187]
    v_mfma_f32_16x16x32_bf16 v[188:191], v[96:99], v[68:71], v[188:191]
    v_mfma_f32_16x16x32_bf16 v[192:195], v[100:103], v[68:71], v[192:195]
    v_mfma_f32_16x16x32_bf16 v[196:199], v[84:87], v[72:75], v[196:199]
    v_mfma_f32_16x16x32_bf16 v[200:203], v[88:91], v[72:75], v[200:203]
    v_mfma_f32_16x16x32_bf16 v[204:207], v[92:95], v[72:75], v[204:207]
    v_mfma_f32_16x16x32_bf16 v[208:211], v[96:99], v[72:75], v[208:211]
    v_mfma_f32_16x16x32_bf16 v[212:215], v[100:103], v[72:75], v[212:215]
    v_mfma_f32_16x16x32_bf16 v[216:219], v[84:87], v[76:79], v[216:219]
    v_mfma_f32_16x16x32_bf16 v[220:223], v[88:91], v[76:79], v[220:223]
    v_mfma_f32_16x16x32_bf16 v[224:227], v[92:95], v[76:79], v[224:227]
    v_mfma_f32_16x16x32_bf16 v[228:231], v[96:99], v[76:79], v[228:231]
    v_mfma_f32_16x16x32_bf16 v[232:235], v[100:103], v[76:79], v[232:235]
    v_mfma_f32_16x16x32_bf16 v[236:239], v[84:87], v[80:83], v[236:239]
    v_mfma_f32_16x16x32_bf16 v[240:243], v[88:91], v[80:83], v[240:243]
    v_mfma_f32_16x16x32_bf16 v[244:247], v[92:95], v[80:83], v[244:247]
    v_mfma_f32_16x16x32_bf16 v[248:251], v[96:99], v[80:83], v[248:251]
    v_mfma_f32_16x16x32_bf16 v[252:255], v[100:103], v[80:83], v[252:255]
    s_waitcnt vmcnt(8)
    v_mfma_f32_16x16x32_bf16 v[176:179], v[120:123], v[104:107], v[176:179]
    v_mfma_f32_16x16x32_bf16 v[180:183], v[124:127], v[104:107], v[180:183]
    v_mfma_f32_16x16x32_bf16 v[184:187], v[128:131], v[104:107], v[184:187]
    v_mfma_f32_16x16x32_bf16 v[188:191], v[132:135], v[104:107], v[188:191]
    v_mfma_f32_16x16x32_bf16 v[192:195], v[136:139], v[104:107], v[192:195]
    v_mfma_f32_16x16x32_bf16 v[196:199], v[120:123], v[108:111], v[196:199]
    v_mfma_f32_16x16x32_bf16 v[200:203], v[124:127], v[108:111], v[200:203]
    v_mfma_f32_16x16x32_bf16 v[204:207], v[128:131], v[108:111], v[204:207]
    v_mfma_f32_16x16x32_bf16 v[208:211], v[132:135], v[108:111], v[208:211]
    v_mfma_f32_16x16x32_bf16 v[212:215], v[136:139], v[108:111], v[212:215]
    v_mfma_f32_16x16x32_bf16 v[216:219], v[120:123], v[112:115], v[216:219]
    v_mfma_f32_16x16x32_bf16 v[220:223], v[124:127], v[112:115], v[220:223]
    v_mfma_f32_16x16x32_bf16 v[224:227], v[128:131], v[112:115], v[224:227]
    v_mfma_f32_16x16x32_bf16 v[228:231], v[132:135], v[112:115], v[228:231]
    v_mfma_f32_16x16x32_bf16 v[232:235], v[136:139], v[112:115], v[232:235]
    v_mfma_f32_16x16x32_bf16 v[236:239], v[120:123], v[116:119], v[236:239]
    v_mfma_f32_16x16x32_bf16 v[240:243], v[124:127], v[116:119], v[240:243]
    v_mfma_f32_16x16x32_bf16 v[244:247], v[128:131], v[116:119], v[244:247]
    v_mfma_f32_16x16x32_bf16 v[248:251], v[132:135], v[116:119], v[248:251]
    v_mfma_f32_16x16x32_bf16 v[252:255], v[136:139], v[116:119], v[252:255]
    s_waitcnt vmcnt(4)
    v_mfma_f32_16x16x32_bf16 v[176:179], v[156:159], v[140:143], v[176:179]
    v_mfma_f32_16x16x32_bf16 v[180:183], v[160:163], v[140:143], v[180:183]
    v_mfma_f32_16x16x32_bf16 v[184:187], v[164:167], v[140:143], v[184:187]
    v_mfma_f32_16x16x32_bf16 v[188:191], v[168:171], v[140:143], v[188:191]
    v_mfma_f32_16x16x32_bf16 v[192:195], v[172:175], v[140:143], v[192:195]
    v_mfma_f32_16x16x32_bf16 v[196:199], v[156:159], v[144:147], v[196:199]
    v_mfma_f32_16x16x32_bf16 v[200:203], v[160:163], v[144:147], v[200:203]
    v_mfma_f32_16x16x32_bf16 v[204:207], v[164:167], v[144:147], v[204:207]
    v_mfma_f32_16x16x32_bf16 v[208:211], v[168:171], v[144:147], v[208:211]
    v_mfma_f32_16x16x32_bf16 v[212:215], v[172:175], v[144:147], v[212:215]
    v_mfma_f32_16x16x32_bf16 v[216:219], v[156:159], v[148:151], v[216:219]
    v_mfma_f32_16x16x32_bf16 v[220:223], v[160:163], v[148:151], v[220:223]
    v_mfma_f32_16x16x32_bf16 v[224:227], v[164:167], v[148:151], v[224:227]
    v_mfma_f32_16x16x32_bf16 v[228:231], v[168:171], v[148:151], v[228:231]
    v_mfma_f32_16x16x32_bf16 v[232:235], v[172:175], v[148:151], v[232:235]
    v_mfma_f32_16x16x32_bf16 v[236:239], v[156:159], v[152:155], v[236:239]
    v_mfma_f32_16x16x32_bf16 v[240:243], v[160:163], v[152:155], v[240:243]
    v_mfma_f32_16x16x32_bf16 v[244:247], v[164:167], v[152:155], v[244:247]
    v_mfma_f32_16x16x32_bf16 v[248:251], v[168:171], v[152:155], v[248:251]
    v_mfma_f32_16x16x32_bf16 v[252:255], v[172:175], v[152:155], v[252:255]
    s_waitcnt vmcnt(0)
    v_mfma_f32_16x16x32_bf16 v[176:179], v[12:15], v[32:35], v[176:179]
    v_mfma_f32_16x16x32_bf16 v[180:183], v[16:19], v[32:35], v[180:183]
    v_mfma_f32_16x16x32_bf16 v[184:187], v[20:23], v[32:35], v[184:187]
    v_mfma_f32_16x16x32_bf16 v[188:191], v[24:27], v[32:35], v[188:191]
    v_mfma_f32_16x16x32_bf16 v[192:195], v[28:31], v[32:35], v[192:195]
    v_mfma_f32_16x16x32_bf16 v[196:199], v[12:15], v[36:39], v[196:199]
    v_mfma_f32_16x16x32_bf16 v[200:203], v[16:19], v[36:39], v[200:203]
    v_mfma_f32_16x16x32_bf16 v[204:207], v[20:23], v[36:39], v[204:207]
    v_mfma_f32_16x16x32_bf16 v[208:211], v[24:27], v[36:39], v[208:211]
    v_mfma_f32_16x16x32_bf16 v[212:215], v[28:31], v[36:39], v[212:215]
    v_mfma_f32_16x16x32_bf16 v[216:219], v[12:15], v[40:43], v[216:219]
    v_mfma_f32_16x16x32_bf16 v[220:223], v[16:19], v[40:43], v[220:223]
    v_mfma_f32_16x16x32_bf16 v[224:227], v[20:23], v[40:43], v[224:227]
    v_mfma_f32_16x16x32_bf16 v[228:231], v[24:27], v[40:43], v[228:231]
    v_mfma_f32_16x16x32_bf16 v[232:235], v[28:31], v[40:43], v[232:235]
    v_mfma_f32_16x16x32_bf16 v[236:239], v[12:15], v[44:47], v[236:239]
    v_mfma_f32_16x16x32_bf16 v[240:243], v[16:19], v[44:47], v[240:243]
    v_mfma_f32_16x16x32_bf16 v[244:247], v[20:23], v[44:47], v[244:247]
    v_mfma_f32_16x16x32_bf16 v[248:251], v[24:27], v[44:47], v[248:251]
    v_mfma_f32_16x16x32_bf16 v[252:255], v[28:31], v[44:47], v[252:255]
    v_lshlrev_b32 v5, 4, v1
    s_lshl_b32 s19, s16, 10
    v_add_u32 v6, s19, v5
    v_add_u32 v7, 65536, v6
    v_add_u32 v8, 131072, v6
    s_lshl_b32 s19, s16, 13
    v_add_u32 v9, s19, v5
    v_add_u32 v10, 65536, v9
    v_add_u32 v11, 131072, v9
    ds_write_b128 v6, v[176:179] offset:0
    ds_write_b128 v6, v[180:183] offset:8192
    ds_write_b128 v6, v[184:187] offset:16384
    ds_write_b128 v6, v[188:191] offset:24576
    ds_write_b128 v6, v[192:195] offset:32768
    ds_write_b128 v6, v[196:199] offset:40960
    ds_write_b128 v6, v[200:203] offset:49152
    ds_write_b128 v6, v[204:207] offset:57344
    ds_write_b128 v7, v[208:211] offset:0
    ds_write_b128 v7, v[212:215] offset:8192
    ds_write_b128 v7, v[216:219] offset:16384
    ds_write_b128 v7, v[220:223] offset:24576
    ds_write_b128 v7, v[224:227] offset:32768
    ds_write_b128 v7, v[228:231] offset:40960
    ds_write_b128 v7, v[232:235] offset:49152
    ds_write_b128 v7, v[236:239] offset:57344
    ds_write_b128 v8, v[240:243] offset:0
    ds_write_b128 v8, v[244:247] offset:8192
    ds_write_b128 v8, v[248:251] offset:16384
    ds_write_b128 v8, v[252:255] offset:24576
    s_and_b32 s19, s17, 15
    s_lshl_b32 s19, s19, 7
    s_lshr_b32 s30, s17, 4
    s_add_u32 s19, s19, s30
    s_mul_i32 s19, s19, 1280
    s_mul_i32 s30, s18, 160
    s_add_u32 s19, s19, s30
    v_and_b32 v2, 15, v1
    v_mul_u32_u24 v2, 2560, v2
    v_lshrrev_b32 v3, 4, v1
    v_lshlrev_b32 v3, 3, v3
    v_add_u32 v2, v2, v3
    s_waitcnt lgkmcnt(0)
    s_barrier
    ds_read_b128 v[32:35], v9 offset:0
    ds_read_b128 v[36:39], v9 offset:1024
    ds_read_b128 v[40:43], v9 offset:2048
    ds_read_b128 v[44:47], v9 offset:3072
    ds_read_b128 v[48:51], v9 offset:4096
    ds_read_b128 v[52:55], v9 offset:5120
    ds_read_b128 v[56:59], v9 offset:6144
    ds_read_b128 v[60:63], v9 offset:7168
    ds_read_b128 v[64:67], v10 offset:0
    ds_read_b128 v[68:71], v10 offset:1024
    ds_read_b128 v[72:75], v10 offset:2048
    ds_read_b128 v[76:79], v10 offset:3072
    ds_read_b128 v[80:83], v10 offset:4096
    ds_read_b128 v[84:87], v10 offset:5120
    ds_read_b128 v[88:91], v10 offset:6144
    ds_read_b128 v[92:95], v10 offset:7168
    s_cmp_ge_u32 s16, 4
    s_cbranch_scc1 P3_SK_45
    ds_read_b128 v[96:99], v11 offset:0
    ds_read_b128 v[100:103], v11 offset:1024
    ds_read_b128 v[104:107], v11 offset:2048
    ds_read_b128 v[108:111], v11 offset:3072
    ds_read_b128 v[112:115], v11 offset:4096
    ds_read_b128 v[116:119], v11 offset:5120
    ds_read_b128 v[120:123], v11 offset:6144
    ds_read_b128 v[124:127], v11 offset:7168
P3_SK_45:
    s_add_u32 s30, s16, 0
    s_mul_i32 s31, s30, 13108
    s_lshr_b32 s31, s31, 16
    s_mul_i32 s33, s31, 5
    s_sub_u32 s33, s30, s33
    s_mul_i32 s31, s31, 40960
    s_lshl_b32 s33, s33, 5
    s_add_u32 s31, s31, s33
    s_add_u32 s31, s31, s19
    s_waitcnt lgkmcnt(8)
    v_add_f32 v32, v32, v48
    v_add_f32 v33, v33, v49
    v_add_f32 v34, v34, v50
    v_add_f32 v35, v35, v51
    v_add_f32 v36, v36, v52
    v_add_f32 v37, v37, v53
    v_add_f32 v38, v38, v54
    v_add_f32 v39, v39, v55
    v_add_f32 v40, v40, v56
    v_add_f32 v41, v41, v57
    v_add_f32 v42, v42, v58
    v_add_f32 v43, v43, v59
    v_add_f32 v44, v44, v60
    v_add_f32 v45, v45, v61
    v_add_f32 v46, v46, v62
    v_add_f32 v47, v47, v63
    v_add_f32 v32, v32, v40
    v_add_f32 v33, v33, v41
    v_add_f32 v34, v34, v42
    v_add_f32 v35, v35, v43
    v_add_f32 v36, v36, v44
    v_add_f32 v37, v37, v45
    v_add_f32 v38, v38, v46
    v_add_f32 v39, v39, v47
    v_add_f32 v32, v32, v36
    v_add_f32 v33, v33, v37
    v_add_f32 v34, v34, v38
    v_add_f32 v35, v35, v39
    v_cvt_pk_bf16_f32 v32, v32, v33
    v_cvt_pk_bf16_f32 v33, v34, v35
    buffer_store_dwordx2 v[32:33], v2, s[4:7], s31 offen
    s_add_u32 s30, s16, 8
    s_mul_i32 s31, s30, 13108
    s_lshr_b32 s31, s31, 16
    s_mul_i32 s33, s31, 5
    s_sub_u32 s33, s30, s33
    s_mul_i32 s31, s31, 40960
    s_lshl_b32 s33, s33, 5
    s_add_u32 s31, s31, s33
    s_add_u32 s31, s31, s19
    s_waitcnt lgkmcnt(0)
    v_add_f32 v64, v64, v80
    v_add_f32 v65, v65, v81
    v_add_f32 v66, v66, v82
    v_add_f32 v67, v67, v83
    v_add_f32 v68, v68, v84
    v_add_f32 v69, v69, v85
    v_add_f32 v70, v70, v86
    v_add_f32 v71, v71, v87
    v_add_f32 v72, v72, v88
    v_add_f32 v73, v73, v89
    v_add_f32 v74, v74, v90
    v_add_f32 v75, v75, v91
    v_add_f32 v76, v76, v92
    v_add_f32 v77, v77, v93
    v_add_f32 v78, v78, v94
    v_add_f32 v79, v79, v95
    v_add_f32 v64, v64, v72
    v_add_f32 v65, v65, v73
    v_add_f32 v66, v66, v74
    v_add_f32 v67, v67, v75
    v_add_f32 v68, v68, v76
    v_add_f32 v69, v69, v77
    v_add_f32 v70, v70, v78
    v_add_f32 v71, v71, v79
    v_add_f32 v64, v64, v68
    v_add_f32 v65, v65, v69
    v_add_f32 v66, v66, v70
    v_add_f32 v67, v67, v71
    v_cvt_pk_bf16_f32 v64, v64, v65
    v_cvt_pk_bf16_f32 v65, v66, v67
    buffer_store_dwordx2 v[64:65], v2, s[4:7], s31 offen
    s_cmp_ge_u32 s16, 4
    s_cbranch_scc1 P3_SK_46
    s_add_u32 s30, s16, 16
    s_mul_i32 s31, s30, 13108
    s_lshr_b32 s31, s31, 16
    s_mul_i32 s33, s31, 5
    s_sub_u32 s33, s30, s33
    s_mul_i32 s31, s31, 40960
    s_lshl_b32 s33, s33, 5
    s_add_u32 s31, s31, s33
    s_add_u32 s31, s31, s19
    s_waitcnt lgkmcnt(0)
    v_add_f32 v96, v96, v112
    v_add_f32 v97, v97, v113
    v_add_f32 v98, v98, v114
    v_add_f32 v99, v99, v115
    v_add_f32 v100, v100, v116
    v_add_f32 v101, v101, v117
    v_add_f32 v102, v102, v118
    v_add_f32 v103, v103, v119
    v_add_f32 v104, v104, v120
    v_add_f32 v105, v105, v121
    v_add_f32 v106, v106, v122
    v_add_f32 v107, v107, v123
    v_add_f32 v108, v108, v124
    v_add_f32 v109, v109, v125
    v_add_f32 v110, v110, v126
    v_add_f32 v111, v111, v127
    v_add_f32 v96, v96, v104
    v_add_f32 v97, v97, v105
    v_add_f32 v98, v98, v106
    v_add_f32 v99, v99, v107
    v_add_f32 v100, v100, v108
    v_add_f32 v101, v101, v109
    v_add_f32 v102, v102, v110
    v_add_f32 v103, v103, v111
    v_add_f32 v96, v96, v100
    v_add_f32 v97, v97, v101
    v_add_f32 v98, v98, v102
    v_add_f32 v99, v99, v103
    v_cvt_pk_bf16_f32 v96, v96, v97
    v_cvt_pk_bf16_f32 v97, v98, v99
    buffer_store_dwordx2 v[96:97], v2, s[4:7], s31 offen
P3_SK_46:
F_FIN:
F_END:
    s_endpgm
P2_SLOW:
    s_add_u32 s30, s27, s26
    s_add_u32 s30, s30, s19
    s_mul_i32 s30, s30, 1280
    s_add_u32 s30, s30, 3932160
    v_mov_b32 v64, 0
    v_mov_b32 v65, 0
    buffer_load_dwordx4 v[60:63], v2, s[8:11], s30 offen sc1
    s_sub_u32 s30, s30, s51
    s_mov_b64 exec, s[22:23]
    buffer_load_dwordx2 v[64:65], v208, s[8:11], s30 offen sc1
    s_mov_b64 exec, -1
    v_mov_b32 v66, 0xff800000
    s_mov_b32 s53, s50
    s_add_u32 s39, s50, 163840
P2_SLOW_MAX:
    buffer_load_dwordx4 v[56:59], v2, s[4:7], s53 offen sc1
    s_sub_u32 s52, s53, s50
    s_mov_b64 exec, s[22:23]
    buffer_load_dwordx2 v[136:137], v3, s[4:7], s52 offen sc1
    s_mov_b64 exec, -1
    s_waitcnt vmcnt(0)
    v_mfma_f32_32x32x16_bf16 v[8:23], v[56:59], v[60:63], 0
    v_mfma_f32_32x32x8_bf16 v[8:23], v[136:137], v[64:65], v[8:23]
    s_nop 12
    v_max3_f32 v66, v66, v8, v9
    v_max3_f32 v66, v66, v10, v11
    v_max3_f32 v66, v66, v12, v13
    v_max3_f32 v66, v66, v14, v15
    v_max3_f32 v66, v66, v16, v17
    v_max3_f32 v66, v66, v18, v19
    v_max3_f32 v66, v66, v20, v21
    v_max3_f32 v66, v66, v22, v23
    s_add_u32 s53, s53, 2560
    s_cmp_lt_u32 s53, s39
    s_cbranch_scc1 P2_SLOW_MAX
    v_mov_b32 v67, v66
    s_nop 1
    v_permlane32_swap_b32 v67, v66
    s_nop 1
    v_max_f32 v66, v67, v66
    v_sub_f32 v67, 0, v66
    v_cvt_pk_bf16_f32 v68, v67, 0
    v_lshlrev_b32 v69, 16, v68
    v_sub_f32 v67, v67, v69
    v_cvt_pk_bf16_f32 v70, v67, 0
    v_lshlrev_b32 v69, 16, v70
    v_sub_f32 v67, v67, v69
    v_cvt_pk_bf16_f32 v71, v67, 0
    v_lshlrev_b32 v70, 16, v70
    v_or_b32 v68, v68, v70
    s_mov_b64 exec, s[56:57]
    v_mov_b32 v64, v68
    v_mov_b32 v65, v71
    s_mov_b64 exec, -1
    v_mov_b32 v40, 0
    v_mov_b32 v41, 0
    v_mov_b32 v42, 0
    v_mov_b32 v43, 0
    v_mov_b32 v44, 0
    v_mov_b32 v45, 0
    v_mov_b32 v46, 0
    v_mov_b32 v47, 0
    v_mov_b32 v48, 0
    v_mov_b32 v49, 0
    v_mov_b32 v50, 0
    v_mov_b32 v51, 0
    v_mov_b32 v52, 0
    v_mov_b32 v53, 0
    v_mov_b32 v54, 0
    v_mov_b32 v55, 0
    s_mov_b32 s53, s50
P2_SLOW_PV:
    buffer_load_dwordx4 v[56:59], v2, s[4:7], s53 offen sc1
    s_sub_u32 s52, s53, s50
    s_mov_b64 exec, s[22:23]
    buffer_load_dwordx2 v[136:137], v3, s[4:7], s52 offen sc1
    s_mov_b64 exec, s[20:21]
    buffer_load_dwordx4 v[140:143], v4, s[4:7], s53 offen sc1
    buffer_load_dwordx4 v[144:147], v4, s[4:7], s53 offen offset:640 sc1
    s_mov_b64 exec, -1
    s_waitcnt vmcnt(0)
    v_mfma_f32_32x32x16_bf16 v[8:23], v[56:59], v[60:63], 0
    v_mfma_f32_32x32x8_bf16 v[8:23], v[136:137], v[64:65], v[8:23]
    s_nop 12
    v_exp_f32 v8, v8
    v_exp_f32 v9, v9
    v_exp_f32 v10, v10
    v_exp_f32 v11, v11
    v_exp_f32 v12, v12
    v_exp_f32 v13, v13
    v_exp_f32 v14, v14
    v_exp_f32 v15, v15
    v_exp_f32 v16, v16
    v_exp_f32 v17, v17
    v_exp_f32 v18, v18
    v_exp_f32 v19, v19
    v_exp_f32 v20, v20
    v_exp_f32 v21, v21
    v_exp_f32 v22, v22
    v_exp_f32 v23, v23
    s_nop 0
    v_cvt_pk_bf16_f32 v24, v8, v9
    v_cvt_pk_bf16_f32 v25, v10, v11
    v_cvt_pk_bf16_f32 v26, v12, v13
    v_cvt_pk_bf16_f32 v27, v14, v15
    v_cvt_pk_bf16_f32 v28, v16, v17
    v_cvt_pk_bf16_f32 v29, v18, v19
    v_cvt_pk_bf16_f32 v30, v20, v21
    v_cvt_pk_bf16_f32 v31, v22, v23
    s_nop 1
    v_mfma_f32_32x32x16_bf16 v[40:55], v[140:143], v[24:27], v[40:55]
    v_mfma_f32_32x32x16_bf16 v[40:55], v[144:147], v[28:31], v[40:55]
    s_add_u32 s53, s53, 2560
    s_cmp_lt_u32 s53, s39
    s_cbranch_scc1 P2_SLOW_PV
    s_nop 12
    s_branch P2_SLOW_RET
F_CODE_END:
    s_endpgm
.section .rodata,"a"
.p2align 6
.amdhsa_kernel gated_mix__sliding_local_dilated__softmax_full_mha__prompt_kernel
  .amdhsa_next_free_vgpr 256
  .amdhsa_next_free_sgpr 64
  .amdhsa_accum_offset 256
  .amdhsa_group_segment_fixed_size 0
  .amdhsa_kernarg_size 80
  .amdhsa_user_sgpr_count 2
  .amdhsa_user_sgpr_kernarg_segment_ptr 1
  .amdhsa_system_sgpr_workgroup_id_x 1
.end_amdhsa_kernel
```
